```python
import torch

def _softmax(x, axis=-1):
    return torch.softmax(x, dim=axis)
def _gelu(x):
    return torch.nn.functional.gelu(x, approximate="tanh")
def _silu(x):
    return torch.nn.functional.silu(x)
def _sigmoid(x):
    return torch.sigmoid(x)
def _layernorm(x, axis=-1, eps=1e-5):
    m = x.mean(dim=axis, keepdim=True)
    v = x.var(dim=axis, keepdim=True, unbiased=False)
    return (x - m) / torch.sqrt(v + eps)
def _scatter_add(tgt, idx, src, axis=0):
    return tgt.clone().index_add_(axis, idx, src)
def _segment_sum(src, seg, n):
    out = torch.zeros((n,) + src.shape[1:], dtype=src.dtype)
    return out.index_add_(0, seg, src)
def _pad(x, pw):
    flat = tuple(v for pair in reversed(pw) for v in pair)
    return torch.nn.functional.pad(x, flat)

kernel_name = 'parallel_sum__mha_block__dense_activation_gelu__prompt'

def setup_inputs():

    _w = (lambda a: (lambda t: t.to(torch.bfloat16) if t.is_floating_point() else t)(torch.as_tensor(a)))
    def _A_setup():
        B, S, D, H = 1, 2048, 512, 32
        return {
            "x": _w((lambda *s: torch.randn(*s, dtype=torch.bfloat16) * 0.05)(B, S, D)),
            "wqkv": _w((lambda *s: torch.randn(*s, dtype=torch.bfloat16) * 0.05)(D, 3 * D)),
            "wo": _w((lambda *s: torch.randn(*s, dtype=torch.bfloat16) * 0.05)(D, D)),
        }
    _A_in = _A_setup()

    def _B_setup():
        B, S, D, F = 1, 2048, 512, 1792
        return {
            "x": _w((lambda *s: torch.randn(*s, dtype=torch.bfloat16) * 0.05)(B, S, D)),
            "w1": _w((lambda *s: torch.randn(*s, dtype=torch.bfloat16) * 0.8)(D, F) * (D ** -0.5)),
            "b1": _w((lambda *s: torch.randn(*s, dtype=torch.bfloat16) * 12.8)(F) * 0.01),
            "w2": _w((lambda *s: torch.randn(*s, dtype=torch.bfloat16) * 0.8)(F, D) * (F ** -0.5)),
            "b2": _w((lambda *s: torch.randn(*s, dtype=torch.bfloat16) * 12.8)(D) * 0.01),
        }
    _B_in = _B_setup()

    return {
        "A_x": _A_in["x"],
        "A_wqkv": _A_in["wqkv"],
        "A_wo": _A_in["wo"],
        "B_x": _B_in["x"],
        "B_w1": _B_in["w1"],
        "B_b1": _B_in["b1"],
        "B_w2": _B_in["w2"],
        "B_b2": _B_in["b2"],
    }

def reference(A_x, A_wqkv, A_wo, B_x, B_w1, B_b1, B_w2, B_b2):
    def _A_ref(x, wqkv, wo):
        B, S, D = x.shape
        H = 32
        Dh = D // H
        qkv = (lambda x, *d: x.permute(*d))((x @ wqkv).reshape(B, S, 3, H, Dh), 2, 0, 3, 1, 4)
        q, k, v = qkv[0], qkv[1], qkv[2]
        scores = torch.einsum("bhqd,bhkd->bhqk", q, k) * (Dh ** -0.5)
        p = _softmax(scores, axis=-1)
        o = torch.einsum("bhqk,bhkd->bhqd", p, v)
        return (lambda x, *d: x.permute(*d))(o, 0, 2, 1, 3).reshape(B, S, D) @ wo

    def _B_ref(x, w1, b1, w2, b2):
        h = torch.einsum("bsd,df->bsf", x, w1) + b1
        h = _gelu(h)
        return torch.einsum("bsf,fd->bsd", h, w2) + b2

    x = A_x
    xn = _layernorm(x, axis=-1)
    return x + _A_ref(xn, A_wqkv, A_wo) + _B_ref(xn, B_w1, B_b1, B_w2, B_b2)
```

```asm
; @launch kernel=mha_k0_kernel grid=(256,1,1) block=(512,1,1) lds=0
; @launch kernel=mha_k1_kernel grid=(208,1,1) block=(512,1,1) lds=147456
; @launch kernel=mha_k2_kernel grid=(512,1,1) block=(512,1,1) lds=74240
; @launch kernel=mha_k3_kernel grid=(256,1,1) block=(256,1,1) lds=49152
.amdgcn_target "amdgcn-amd-amdhsa--gfx950"
.text
.globl mha_k0_kernel
.p2align 8
.type mha_k0_kernel,@function
mha_k0_kernel:
s_cmp_ge_u32 s2, 256
s_cbranch_scc1 K0_END
s_load_dwordx2 s[4:5], s[0:1], 0
s_load_dwordx2 s[6:7], s[0:1], 80
v_lshrrev_b32 v10, 6, v0
v_and_b32 v11, 63, v0
s_lshl_b32 s3, s2, 3
v_add_u32 v10, s3, v10
v_lshlrev_b32 v10, 10, v10
v_lshl_add_u32 v10, v11, 4, v10
s_waitcnt lgkmcnt(0)
s_mov_b32 s8, s4
s_mov_b32 s9, s5
s_mov_b32 s10, 2097152
s_mov_b32 s11, 0x00020000
s_add_u32 s12, s6, 16777216
s_addc_u32 s13, s7, 0
s_mov_b32 s14, 2097152
s_mov_b32 s15, 0x00020000
buffer_load_dwordx4 v[0:3], v10, s[8:11], 0 offen
s_waitcnt vmcnt(0)
v_lshlrev_b32 v12, 16, v0
v_and_b32 v13, 0xffff0000, v0
v_lshlrev_b32 v14, 16, v1
v_and_b32 v15, 0xffff0000, v1
v_lshlrev_b32 v16, 16, v2
v_and_b32 v17, 0xffff0000, v2
v_lshlrev_b32 v18, 16, v3
v_and_b32 v19, 0xffff0000, v3
v_add_f32 v20, v12, v13
v_add_f32 v20, v20, v14
v_add_f32 v20, v20, v15
v_add_f32 v20, v20, v16
v_add_f32 v20, v20, v17
v_add_f32 v20, v20, v18
v_add_f32 v20, v20, v19
ds_swizzle_b32 v21, v20 offset:1055
s_waitcnt lgkmcnt(0)
v_add_f32 v20, v20, v21
ds_swizzle_b32 v21, v20 offset:2079
s_waitcnt lgkmcnt(0)
v_add_f32 v20, v20, v21
ds_swizzle_b32 v21, v20 offset:4127
s_waitcnt lgkmcnt(0)
v_add_f32 v20, v20, v21
ds_swizzle_b32 v21, v20 offset:8223
s_waitcnt lgkmcnt(0)
v_add_f32 v20, v20, v21
ds_swizzle_b32 v21, v20 offset:16415
s_waitcnt lgkmcnt(0)
v_add_f32 v20, v20, v21
v_mov_b32 v21, v20
s_nop 1
v_permlane32_swap_b32 v20, v21
s_nop 1
v_add_f32 v20, v20, v21
v_mul_f32 v20, 0x3b000000, v20
v_sub_f32 v22, v12, v20
v_mul_f32 v23, v22, v22
v_sub_f32 v22, v13, v20
v_fmac_f32 v23, v22, v22
v_sub_f32 v22, v14, v20
v_fmac_f32 v23, v22, v22
v_sub_f32 v22, v15, v20
v_fmac_f32 v23, v22, v22
v_sub_f32 v22, v16, v20
v_fmac_f32 v23, v22, v22
v_sub_f32 v22, v17, v20
v_fmac_f32 v23, v22, v22
v_sub_f32 v22, v18, v20
v_fmac_f32 v23, v22, v22
v_sub_f32 v22, v19, v20
v_fmac_f32 v23, v22, v22
ds_swizzle_b32 v21, v23 offset:1055
s_waitcnt lgkmcnt(0)
v_add_f32 v23, v23, v21
ds_swizzle_b32 v21, v23 offset:2079
s_waitcnt lgkmcnt(0)
v_add_f32 v23, v23, v21
ds_swizzle_b32 v21, v23 offset:4127
s_waitcnt lgkmcnt(0)
v_add_f32 v23, v23, v21
ds_swizzle_b32 v21, v23 offset:8223
s_waitcnt lgkmcnt(0)
v_add_f32 v23, v23, v21
ds_swizzle_b32 v21, v23 offset:16415
s_waitcnt lgkmcnt(0)
v_add_f32 v23, v23, v21
v_mov_b32 v21, v23
s_nop 1
v_permlane32_swap_b32 v23, v21
s_nop 1
v_add_f32 v23, v23, v21
v_mul_f32 v23, 0x3b000000, v23
v_cvt_pk_bf16_f32 v21, v20, v20
v_lshlrev_b32 v20, 16, v21
v_cvt_pk_bf16_f32 v21, v23, v23
v_lshlrev_b32 v23, 16, v21
v_add_f32 v23, 0x3727c5ac, v23
v_cvt_pk_bf16_f32 v21, v23, v23
v_lshlrev_b32 v23, 16, v21
v_sqrt_f32 v23, v23
s_nop 0
v_cvt_pk_bf16_f32 v21, v23, v23
v_lshlrev_b32 v23, 16, v21
v_rcp_f32 v23, v23
s_nop 0
v_sub_f32 v12, v12, v20
v_sub_f32 v13, v13, v20
v_cvt_pk_bf16_f32 v0, v12, v13
v_lshlrev_b32 v12, 16, v0
v_and_b32 v13, 0xffff0000, v0
v_mul_f32 v12, v12, v23
v_mul_f32 v13, v13, v23
v_cvt_pk_bf16_f32 v0, v12, v13
v_sub_f32 v14, v14, v20
v_sub_f32 v15, v15, v20
v_cvt_pk_bf16_f32 v1, v14, v15
v_lshlrev_b32 v14, 16, v1
v_and_b32 v15, 0xffff0000, v1
v_mul_f32 v14, v14, v23
v_mul_f32 v15, v15, v23
v_cvt_pk_bf16_f32 v1, v14, v15
v_sub_f32 v16, v16, v20
v_sub_f32 v17, v17, v20
v_cvt_pk_bf16_f32 v2, v16, v17
v_lshlrev_b32 v16, 16, v2
v_and_b32 v17, 0xffff0000, v2
v_mul_f32 v16, v16, v23
v_mul_f32 v17, v17, v23
v_cvt_pk_bf16_f32 v2, v16, v17
v_sub_f32 v18, v18, v20
v_sub_f32 v19, v19, v20
v_cvt_pk_bf16_f32 v3, v18, v19
v_lshlrev_b32 v18, 16, v3
v_and_b32 v19, 0xffff0000, v3
v_mul_f32 v18, v18, v23
v_mul_f32 v19, v19, v23
v_cvt_pk_bf16_f32 v3, v18, v19
buffer_store_dwordx4 v[0:3], v10, s[12:15], 0 offen
s_waitcnt vmcnt(0)
K0_END:
s_endpgm
.section .rodata,"a"
.p2align 6
.amdhsa_kernel mha_k0_kernel
  .amdhsa_next_free_vgpr 32
  .amdhsa_next_free_sgpr 96
  .amdhsa_accum_offset 32
  .amdhsa_group_segment_fixed_size 0
  .amdhsa_kernarg_size 88
  .amdhsa_user_sgpr_count 2
  .amdhsa_user_sgpr_kernarg_segment_ptr 1
  .amdhsa_system_sgpr_workgroup_id_x 1
.end_amdhsa_kernel
.text
.globl mha_k1_kernel
.p2align 8
.type mha_k1_kernel,@function
mha_k1_kernel:
s_cmp_ge_u32 s2, 208
s_cbranch_scc1 K1_END
s_load_dwordx2 s[4:5], s[0:1], 0
s_load_dwordx2 s[6:7], s[0:1], 8
s_load_dwordx2 s[20:21], s[0:1], 32
s_load_dwordx2 s[22:23], s[0:1], 40
s_load_dwordx2 s[24:25], s[0:1], 80

s_lshr_b32 s26, s2, 4
s_and_b32 s27, s2, 15
v_lshrrev_b32 v2, 6, v0
v_and_b32 v1, 63, v0
v_readfirstlane_b32 s28, v2
s_and_b32 s29, s28, 1
s_lshr_b32 s30, s28, 1
s_waitcnt lgkmcnt(0)
s_add_u32 s8, s24, 0x1000000
s_addc_u32 s9, s25, 0
s_mov_b32 s10, 2097152
s_mov_b32 s11, 0x00020000
s_mov_b32 s16, s24
s_mov_b32 s17, s25
s_mov_b32 s18, 268435456
s_mov_b32 s19, 0x00020000
s_cmp_lt_u32 s26, 6
s_cselect_b32 s12, s6, s20
s_cselect_b32 s13, s7, s21
s_mov_b32 s31, 3584
s_cselect_b32 s31, 3072, s31
s_sub_u32 s32, s26, 6
s_cselect_b32 s32, s26, s32
s_lshl_b32 s32, s32, 9
s_lshl_b32 s14, s31, 9
s_mov_b32 s15, 0x00020000
v_lshrrev_b32 v2, 5, v1
s_lshl_b32 s34, s28, 3
v_and_b32 v4, 31, v1
v_add_u32 v3, 0, v2
v_and_b32 v6, 3, v3
v_lshlrev_b32 v6, 2, v6
v_xor_b32 v6, v6, v4
v_lshlrev_b32 v6, 4, v6
v_add_u32 v3, s34, v3
v_mul_lo_u32 v14, v3, s31
v_add_u32 v14, v14, v6
v_add_u32 v3, 2, v2
v_and_b32 v6, 3, v3
v_lshlrev_b32 v6, 2, v6
v_xor_b32 v6, v6, v4
v_lshlrev_b32 v6, 4, v6
v_add_u32 v3, s34, v3
v_mul_lo_u32 v15, v3, s31
v_add_u32 v15, v15, v6
v_add_u32 v3, 4, v2
v_and_b32 v6, 3, v3
v_lshlrev_b32 v6, 2, v6
v_xor_b32 v6, v6, v4
v_lshlrev_b32 v6, 4, v6
v_add_u32 v3, s34, v3
v_mul_lo_u32 v16, v3, s31
v_add_u32 v16, v16, v6
v_add_u32 v3, 6, v2
v_and_b32 v6, 3, v3
v_lshlrev_b32 v6, 2, v6
v_xor_b32 v6, v6, v4
v_lshlrev_b32 v6, 4, v6
v_add_u32 v3, s34, v3
v_mul_lo_u32 v17, v3, s31
v_add_u32 v17, v17, v6
s_lshl_b32 s36, s31, 6
s_lshl_b32 s37, s28, 12
v_lshrrev_b32 v2, 3, v1
v_and_b32 v3, 7, v1
v_xor_b32 v3, v3, v2
s_lshl_b32 s33, s28, 1
s_and_b32 s33, s33, 3
v_xor_b32 v3, s33, v3
s_lshl_b32 s38, s27, 7
s_lshl_b32 s39, s28, 4
s_add_u32 s39, s39, s38
v_add_u32 v2, s39, v2
v_lshlrev_b32 v2, 10, v2
v_lshl_add_u32 v5, v3, 4, v2
s_lshl_b32 s39, s28, 11
s_add_u32 s39, s39, 32768
s_add_u32 m0, s37, 0
s_mul_i32 s40, s36, 0
s_add_u32 s40, s40, s32
buffer_load_dwordx4 v14, s[12:15], s40 offen lds
s_add_u32 m0, s37, 1024
s_mul_i32 s40, s36, 0
s_add_u32 s40, s40, s32
buffer_load_dwordx4 v15, s[12:15], s40 offen lds
s_add_u32 m0, s37, 2048
s_mul_i32 s40, s36, 0
s_add_u32 s40, s40, s32
buffer_load_dwordx4 v16, s[12:15], s40 offen lds
s_add_u32 m0, s37, 3072
s_mul_i32 s40, s36, 0
s_add_u32 s40, s40, s32
buffer_load_dwordx4 v17, s[12:15], s40 offen lds
s_add_u32 m0, s39, 0
s_mov_b32 s40, 0
buffer_load_dwordx4 v5, s[8:11], s40 offen lds
s_add_u32 m0, s39, 1024
s_mov_b32 s40, 8192
v_xor_b32 v6, 16, v5
buffer_load_dwordx4 v6, s[8:11], s40 offen lds
s_add_u32 m0, s37, 49152
s_mul_i32 s40, s36, 1
s_add_u32 s40, s40, s32
buffer_load_dwordx4 v14, s[12:15], s40 offen lds
s_add_u32 m0, s37, 50176
s_mul_i32 s40, s36, 1
s_add_u32 s40, s40, s32
buffer_load_dwordx4 v15, s[12:15], s40 offen lds
s_add_u32 m0, s37, 51200
s_mul_i32 s40, s36, 1
s_add_u32 s40, s40, s32
buffer_load_dwordx4 v16, s[12:15], s40 offen lds
s_add_u32 m0, s37, 52224
s_mul_i32 s40, s36, 1
s_add_u32 s40, s40, s32
buffer_load_dwordx4 v17, s[12:15], s40 offen lds
s_add_u32 m0, s39, 49152
s_mov_b32 s40, 128
buffer_load_dwordx4 v5, s[8:11], s40 offen lds
s_add_u32 m0, s39, 50176
s_mov_b32 s40, 8320
v_xor_b32 v6, 16, v5
buffer_load_dwordx4 v6, s[8:11], s40 offen lds
v_lshrrev_b32 v2, 5, v1
v_and_b32 v3, 15, v1
v_lshrrev_b32 v4, 2, v3
v_lshl_add_u32 v6, v2, 3, v4
v_lshlrev_b32 v6, 9, v6
v_and_b32 v3, 3, v3
v_lshl_add_u32 v6, v3, 3, v6
v_lshrrev_b32 v2, 4, v1
v_and_b32 v2, 1, v2
v_lshl_add_u32 v6, v2, 5, v6
s_lshl_b32 s40, s30, 1
s_add_u32 s41, s40, 0
v_xor_b32 v2, s41, v4
v_lshl_add_u32 v8, v2, 6, v6
s_add_u32 s41, s40, 1
v_xor_b32 v2, s41, v4
v_lshl_add_u32 v9, v2, 6, v6
v_and_b32 v2, 31, v1
s_lshl_b32 s40, s29, 6
v_add_u32 v3, s40, v2
v_lshlrev_b32 v3, 7, v3
v_add_u32 v3, 32768, v3
v_and_b32 v4, 7, v2
v_lshrrev_b32 v2, 3, v2
v_xor_b32 v4, v4, v2
v_lshrrev_b32 v2, 5, v1
v_xor_b32 v4, v4, v2
v_lshl_add_u32 v10, v4, 4, v3
v_xor_b32 v11, 32, v10
v_xor_b32 v12, 64, v10
v_xor_b32 v13, 96, v10
v_mov_b32 v48, 0
v_mov_b32 v49, 0
v_mov_b32 v50, 0
v_mov_b32 v51, 0
v_mov_b32 v52, 0
v_mov_b32 v53, 0
v_mov_b32 v54, 0
v_mov_b32 v55, 0
v_mov_b32 v56, 0
v_mov_b32 v57, 0
v_mov_b32 v58, 0
v_mov_b32 v59, 0
v_mov_b32 v60, 0
v_mov_b32 v61, 0
v_mov_b32 v62, 0
v_mov_b32 v63, 0
v_mov_b32 v64, 0
v_mov_b32 v65, 0
v_mov_b32 v66, 0
v_mov_b32 v67, 0
v_mov_b32 v68, 0
v_mov_b32 v69, 0
v_mov_b32 v70, 0
v_mov_b32 v71, 0
v_mov_b32 v72, 0
v_mov_b32 v73, 0
v_mov_b32 v74, 0
v_mov_b32 v75, 0
v_mov_b32 v76, 0
v_mov_b32 v77, 0
v_mov_b32 v78, 0
v_mov_b32 v79, 0
v_mov_b32 v80, 0
v_mov_b32 v81, 0
v_mov_b32 v82, 0
v_mov_b32 v83, 0
v_mov_b32 v84, 0
v_mov_b32 v85, 0
v_mov_b32 v86, 0
v_mov_b32 v87, 0
v_mov_b32 v88, 0
v_mov_b32 v89, 0
v_mov_b32 v90, 0
v_mov_b32 v91, 0
v_mov_b32 v92, 0
v_mov_b32 v93, 0
v_mov_b32 v94, 0
v_mov_b32 v95, 0
v_mov_b32 v96, 0
v_mov_b32 v97, 0
v_mov_b32 v98, 0
v_mov_b32 v99, 0
v_mov_b32 v100, 0
v_mov_b32 v101, 0
v_mov_b32 v102, 0
v_mov_b32 v103, 0
v_mov_b32 v104, 0
v_mov_b32 v105, 0
v_mov_b32 v106, 0
v_mov_b32 v107, 0
v_mov_b32 v108, 0
v_mov_b32 v109, 0
v_mov_b32 v110, 0
v_mov_b32 v111, 0
s_mov_b32 s4, s22
s_mov_b32 s5, s23
s_mov_b32 s6, 3584
s_mov_b32 s7, 0x00020000
s_lshl_b32 s46, s30, 7
s_add_u32 s45, s32, s46
v_lshrrev_b32 v2, 5, v1
v_lshlrev_b32 v2, 3, v2
buffer_load_dwordx2 v[144:145], v2, s[4:7], s45 offen offset:0
buffer_load_dwordx2 v[146:147], v2, s[4:7], s45 offen offset:16
buffer_load_dwordx2 v[148:149], v2, s[4:7], s45 offen offset:32
buffer_load_dwordx2 v[150:151], v2, s[4:7], s45 offen offset:48
buffer_load_dwordx2 v[152:153], v2, s[4:7], s45 offen offset:64
buffer_load_dwordx2 v[154:155], v2, s[4:7], s45 offen offset:80
buffer_load_dwordx2 v[156:157], v2, s[4:7], s45 offen offset:96
buffer_load_dwordx2 v[158:159], v2, s[4:7], s45 offen offset:112
s_waitcnt vmcnt(14) lgkmcnt(0)
s_barrier
ds_read_b64_tr_b16 v[112:113], v8 offset:0
ds_read_b64_tr_b16 v[114:115], v8 offset:2048
ds_read_b128 v[128:131], v10 offset:0
ds_read_b64_tr_b16 v[116:117], v9 offset:0
ds_read_b64_tr_b16 v[118:119], v9 offset:2048
ds_read_b128 v[132:135], v10 offset:4096
s_waitcnt lgkmcnt(0)
v_mfma_f32_32x32x16_bf16 v[48:63], v[112:115], v[128:131], v[48:63]
ds_read_b64_tr_b16 v[120:121], v8 offset:8192
ds_read_b64_tr_b16 v[122:123], v8 offset:10240
v_mfma_f32_32x32x16_bf16 v[80:95], v[112:115], v[132:135], v[80:95]
ds_read_b128 v[136:139], v11 offset:0
ds_read_b64_tr_b16 v[124:125], v9 offset:8192
s_add_u32 m0, s37, 98304
s_mul_i32 s40, s36, 2
s_add_u32 s40, s40, s32
buffer_load_dwordx4 v14, s[12:15], s40 offen lds
v_mfma_f32_32x32x16_bf16 v[64:79], v[116:119], v[128:131], v[64:79]
ds_read_b64_tr_b16 v[126:127], v9 offset:10240
ds_read_b128 v[140:143], v11 offset:4096
v_mfma_f32_32x32x16_bf16 v[96:111], v[116:119], v[132:135], v[96:111]
s_add_u32 m0, s37, 99328
s_mul_i32 s40, s36, 2
s_add_u32 s40, s40, s32
buffer_load_dwordx4 v15, s[12:15], s40 offen lds
s_waitcnt lgkmcnt(0)
v_mfma_f32_32x32x16_bf16 v[48:63], v[120:123], v[136:139], v[48:63]
ds_read_b64_tr_b16 v[112:113], v8 offset:16384
ds_read_b64_tr_b16 v[114:115], v8 offset:18432
v_mfma_f32_32x32x16_bf16 v[80:95], v[120:123], v[140:143], v[80:95]
ds_read_b128 v[128:131], v12 offset:0
ds_read_b64_tr_b16 v[116:117], v9 offset:16384
s_add_u32 m0, s37, 100352
s_mul_i32 s40, s36, 2
s_add_u32 s40, s40, s32
buffer_load_dwordx4 v16, s[12:15], s40 offen lds
v_mfma_f32_32x32x16_bf16 v[64:79], v[124:127], v[136:139], v[64:79]
ds_read_b64_tr_b16 v[118:119], v9 offset:18432
ds_read_b128 v[132:135], v12 offset:4096
v_mfma_f32_32x32x16_bf16 v[96:111], v[124:127], v[140:143], v[96:111]
s_add_u32 m0, s37, 101376
s_mul_i32 s40, s36, 2
s_add_u32 s40, s40, s32
buffer_load_dwordx4 v17, s[12:15], s40 offen lds
s_waitcnt lgkmcnt(0)
v_mfma_f32_32x32x16_bf16 v[48:63], v[112:115], v[128:131], v[48:63]
ds_read_b64_tr_b16 v[120:121], v8 offset:24576
ds_read_b64_tr_b16 v[122:123], v8 offset:26624
v_mfma_f32_32x32x16_bf16 v[80:95], v[112:115], v[132:135], v[80:95]
ds_read_b128 v[136:139], v13 offset:0
ds_read_b64_tr_b16 v[124:125], v9 offset:24576
s_add_u32 m0, s39, 98304
s_mov_b32 s40, 256
buffer_load_dwordx4 v5, s[8:11], s40 offen lds
v_mfma_f32_32x32x16_bf16 v[64:79], v[116:119], v[128:131], v[64:79]
ds_read_b64_tr_b16 v[126:127], v9 offset:26624
ds_read_b128 v[140:143], v13 offset:4096
v_mfma_f32_32x32x16_bf16 v[96:111], v[116:119], v[132:135], v[96:111]
s_add_u32 m0, s39, 99328
s_mov_b32 s40, 8448
v_xor_b32 v6, 16, v5
buffer_load_dwordx4 v6, s[8:11], s40 offen lds
s_waitcnt lgkmcnt(0)
s_waitcnt vmcnt(6)
s_barrier
v_add_u32 v8, 49152, v8
v_add_u32 v9, 49152, v9
v_add_u32 v10, 49152, v10
v_add_u32 v11, 49152, v11
v_add_u32 v12, 49152, v12
v_add_u32 v13, 49152, v13
v_mfma_f32_32x32x16_bf16 v[48:63], v[120:123], v[136:139], v[48:63]
ds_read_b64_tr_b16 v[112:113], v8 offset:0
ds_read_b64_tr_b16 v[114:115], v8 offset:2048
v_mfma_f32_32x32x16_bf16 v[80:95], v[120:123], v[140:143], v[80:95]
ds_read_b128 v[128:131], v10 offset:0
ds_read_b64_tr_b16 v[116:117], v9 offset:0
s_add_u32 m0, s37, 0
s_mul_i32 s40, s36, 3
s_add_u32 s40, s40, s32
buffer_load_dwordx4 v14, s[12:15], s40 offen lds
v_mfma_f32_32x32x16_bf16 v[64:79], v[124:127], v[136:139], v[64:79]
ds_read_b64_tr_b16 v[118:119], v9 offset:2048
ds_read_b128 v[132:135], v10 offset:4096
v_mfma_f32_32x32x16_bf16 v[96:111], v[124:127], v[140:143], v[96:111]
s_add_u32 m0, s37, 1024
s_mul_i32 s40, s36, 3
s_add_u32 s40, s40, s32
buffer_load_dwordx4 v15, s[12:15], s40 offen lds
s_waitcnt lgkmcnt(0)
v_mfma_f32_32x32x16_bf16 v[48:63], v[112:115], v[128:131], v[48:63]
ds_read_b64_tr_b16 v[120:121], v8 offset:8192
ds_read_b64_tr_b16 v[122:123], v8 offset:10240
v_mfma_f32_32x32x16_bf16 v[80:95], v[112:115], v[132:135], v[80:95]
ds_read_b128 v[136:139], v11 offset:0
ds_read_b64_tr_b16 v[124:125], v9 offset:8192
s_add_u32 m0, s37, 2048
s_mul_i32 s40, s36, 3
s_add_u32 s40, s40, s32
buffer_load_dwordx4 v16, s[12:15], s40 offen lds
v_mfma_f32_32x32x16_bf16 v[64:79], v[116:119], v[128:131], v[64:79]
ds_read_b64_tr_b16 v[126:127], v9 offset:10240
ds_read_b128 v[140:143], v11 offset:4096
v_mfma_f32_32x32x16_bf16 v[96:111], v[116:119], v[132:135], v[96:111]
s_add_u32 m0, s37, 3072
s_mul_i32 s40, s36, 3
s_add_u32 s40, s40, s32
buffer_load_dwordx4 v17, s[12:15], s40 offen lds
s_waitcnt lgkmcnt(0)
v_mfma_f32_32x32x16_bf16 v[48:63], v[120:123], v[136:139], v[48:63]
ds_read_b64_tr_b16 v[112:113], v8 offset:16384
ds_read_b64_tr_b16 v[114:115], v8 offset:18432
v_mfma_f32_32x32x16_bf16 v[80:95], v[120:123], v[140:143], v[80:95]
ds_read_b128 v[128:131], v12 offset:0
ds_read_b64_tr_b16 v[116:117], v9 offset:16384
s_add_u32 m0, s39, 0
s_mov_b32 s40, 384
buffer_load_dwordx4 v5, s[8:11], s40 offen lds
v_mfma_f32_32x32x16_bf16 v[64:79], v[124:127], v[136:139], v[64:79]
ds_read_b64_tr_b16 v[118:119], v9 offset:18432
ds_read_b128 v[132:135], v12 offset:4096
v_mfma_f32_32x32x16_bf16 v[96:111], v[124:127], v[140:143], v[96:111]
s_add_u32 m0, s39, 1024
s_mov_b32 s40, 8576
v_xor_b32 v6, 16, v5
buffer_load_dwordx4 v6, s[8:11], s40 offen lds
s_waitcnt lgkmcnt(0)
v_mfma_f32_32x32x16_bf16 v[48:63], v[112:115], v[128:131], v[48:63]
ds_read_b64_tr_b16 v[120:121], v8 offset:24576
ds_read_b64_tr_b16 v[122:123], v8 offset:26624
v_mfma_f32_32x32x16_bf16 v[80:95], v[112:115], v[132:135], v[80:95]
ds_read_b128 v[136:139], v13 offset:0
ds_read_b64_tr_b16 v[124:125], v9 offset:24576
v_mfma_f32_32x32x16_bf16 v[64:79], v[116:119], v[128:131], v[64:79]
ds_read_b64_tr_b16 v[126:127], v9 offset:26624
ds_read_b128 v[140:143], v13 offset:4096
v_mfma_f32_32x32x16_bf16 v[96:111], v[116:119], v[132:135], v[96:111]
s_waitcnt lgkmcnt(0)
s_waitcnt vmcnt(6)
s_barrier
v_add_u32 v8, 49152, v8
v_add_u32 v9, 49152, v9
v_add_u32 v10, 49152, v10
v_add_u32 v11, 49152, v11
v_add_u32 v12, 49152, v12
v_add_u32 v13, 49152, v13
v_mfma_f32_32x32x16_bf16 v[48:63], v[120:123], v[136:139], v[48:63]
ds_read_b64_tr_b16 v[112:113], v8 offset:0
ds_read_b64_tr_b16 v[114:115], v8 offset:2048
v_mfma_f32_32x32x16_bf16 v[80:95], v[120:123], v[140:143], v[80:95]
ds_read_b128 v[128:131], v10 offset:0
ds_read_b64_tr_b16 v[116:117], v9 offset:0
s_add_u32 m0, s37, 49152
s_mul_i32 s40, s36, 4
s_add_u32 s40, s40, s32
buffer_load_dwordx4 v14, s[12:15], s40 offen lds
v_mfma_f32_32x32x16_bf16 v[64:79], v[124:127], v[136:139], v[64:79]
ds_read_b64_tr_b16 v[118:119], v9 offset:2048
ds_read_b128 v[132:135], v10 offset:4096
v_mfma_f32_32x32x16_bf16 v[96:111], v[124:127], v[140:143], v[96:111]
s_add_u32 m0, s37, 50176
s_mul_i32 s40, s36, 4
s_add_u32 s40, s40, s32
buffer_load_dwordx4 v15, s[12:15], s40 offen lds
s_waitcnt lgkmcnt(0)
v_mfma_f32_32x32x16_bf16 v[48:63], v[112:115], v[128:131], v[48:63]
ds_read_b64_tr_b16 v[120:121], v8 offset:8192
ds_read_b64_tr_b16 v[122:123], v8 offset:10240
v_mfma_f32_32x32x16_bf16 v[80:95], v[112:115], v[132:135], v[80:95]
ds_read_b128 v[136:139], v11 offset:0
ds_read_b64_tr_b16 v[124:125], v9 offset:8192
s_add_u32 m0, s37, 51200
s_mul_i32 s40, s36, 4
s_add_u32 s40, s40, s32
buffer_load_dwordx4 v16, s[12:15], s40 offen lds
v_mfma_f32_32x32x16_bf16 v[64:79], v[116:119], v[128:131], v[64:79]
ds_read_b64_tr_b16 v[126:127], v9 offset:10240
ds_read_b128 v[140:143], v11 offset:4096
v_mfma_f32_32x32x16_bf16 v[96:111], v[116:119], v[132:135], v[96:111]
s_add_u32 m0, s37, 52224
s_mul_i32 s40, s36, 4
s_add_u32 s40, s40, s32
buffer_load_dwordx4 v17, s[12:15], s40 offen lds
s_waitcnt lgkmcnt(0)
v_mfma_f32_32x32x16_bf16 v[48:63], v[120:123], v[136:139], v[48:63]
ds_read_b64_tr_b16 v[112:113], v8 offset:16384
ds_read_b64_tr_b16 v[114:115], v8 offset:18432
v_mfma_f32_32x32x16_bf16 v[80:95], v[120:123], v[140:143], v[80:95]
ds_read_b128 v[128:131], v12 offset:0
ds_read_b64_tr_b16 v[116:117], v9 offset:16384
s_add_u32 m0, s39, 49152
s_mov_b32 s40, 512
buffer_load_dwordx4 v5, s[8:11], s40 offen lds
v_mfma_f32_32x32x16_bf16 v[64:79], v[124:127], v[136:139], v[64:79]
ds_read_b64_tr_b16 v[118:119], v9 offset:18432
ds_read_b128 v[132:135], v12 offset:4096
v_mfma_f32_32x32x16_bf16 v[96:111], v[124:127], v[140:143], v[96:111]
s_add_u32 m0, s39, 50176
s_mov_b32 s40, 8704
v_xor_b32 v6, 16, v5
buffer_load_dwordx4 v6, s[8:11], s40 offen lds
s_waitcnt lgkmcnt(0)
v_mfma_f32_32x32x16_bf16 v[48:63], v[112:115], v[128:131], v[48:63]
ds_read_b64_tr_b16 v[120:121], v8 offset:24576
ds_read_b64_tr_b16 v[122:123], v8 offset:26624
v_mfma_f32_32x32x16_bf16 v[80:95], v[112:115], v[132:135], v[80:95]
ds_read_b128 v[136:139], v13 offset:0
ds_read_b64_tr_b16 v[124:125], v9 offset:24576
v_mfma_f32_32x32x16_bf16 v[64:79], v[116:119], v[128:131], v[64:79]
ds_read_b64_tr_b16 v[126:127], v9 offset:26624
ds_read_b128 v[140:143], v13 offset:4096
v_mfma_f32_32x32x16_bf16 v[96:111], v[116:119], v[132:135], v[96:111]
s_waitcnt lgkmcnt(0)
s_waitcnt vmcnt(6)
s_barrier
v_add_u32 v8, 0xfffe8000, v8
v_add_u32 v9, 0xfffe8000, v9
v_add_u32 v10, 0xfffe8000, v10
v_add_u32 v11, 0xfffe8000, v11
v_add_u32 v12, 0xfffe8000, v12
v_add_u32 v13, 0xfffe8000, v13
v_mfma_f32_32x32x16_bf16 v[48:63], v[120:123], v[136:139], v[48:63]
ds_read_b64_tr_b16 v[112:113], v8 offset:0
ds_read_b64_tr_b16 v[114:115], v8 offset:2048
v_mfma_f32_32x32x16_bf16 v[80:95], v[120:123], v[140:143], v[80:95]
ds_read_b128 v[128:131], v10 offset:0
ds_read_b64_tr_b16 v[116:117], v9 offset:0
s_add_u32 m0, s37, 98304
s_mul_i32 s40, s36, 5
s_add_u32 s40, s40, s32
buffer_load_dwordx4 v14, s[12:15], s40 offen lds
v_mfma_f32_32x32x16_bf16 v[64:79], v[124:127], v[136:139], v[64:79]
ds_read_b64_tr_b16 v[118:119], v9 offset:2048
ds_read_b128 v[132:135], v10 offset:4096
v_mfma_f32_32x32x16_bf16 v[96:111], v[124:127], v[140:143], v[96:111]
s_add_u32 m0, s37, 99328
s_mul_i32 s40, s36, 5
s_add_u32 s40, s40, s32
buffer_load_dwordx4 v15, s[12:15], s40 offen lds
s_waitcnt lgkmcnt(0)
v_mfma_f32_32x32x16_bf16 v[48:63], v[112:115], v[128:131], v[48:63]
ds_read_b64_tr_b16 v[120:121], v8 offset:8192
ds_read_b64_tr_b16 v[122:123], v8 offset:10240
v_mfma_f32_32x32x16_bf16 v[80:95], v[112:115], v[132:135], v[80:95]
ds_read_b128 v[136:139], v11 offset:0
ds_read_b64_tr_b16 v[124:125], v9 offset:8192
s_add_u32 m0, s37, 100352
s_mul_i32 s40, s36, 5
s_add_u32 s40, s40, s32
buffer_load_dwordx4 v16, s[12:15], s40 offen lds
v_mfma_f32_32x32x16_bf16 v[64:79], v[116:119], v[128:131], v[64:79]
ds_read_b64_tr_b16 v[126:127], v9 offset:10240
ds_read_b128 v[140:143], v11 offset:4096
v_mfma_f32_32x32x16_bf16 v[96:111], v[116:119], v[132:135], v[96:111]
s_add_u32 m0, s37, 101376
s_mul_i32 s40, s36, 5
s_add_u32 s40, s40, s32
buffer_load_dwordx4 v17, s[12:15], s40 offen lds
s_waitcnt lgkmcnt(0)
v_mfma_f32_32x32x16_bf16 v[48:63], v[120:123], v[136:139], v[48:63]
ds_read_b64_tr_b16 v[112:113], v8 offset:16384
ds_read_b64_tr_b16 v[114:115], v8 offset:18432
v_mfma_f32_32x32x16_bf16 v[80:95], v[120:123], v[140:143], v[80:95]
ds_read_b128 v[128:131], v12 offset:0
ds_read_b64_tr_b16 v[116:117], v9 offset:16384
s_add_u32 m0, s39, 98304
s_mov_b32 s40, 640
buffer_load_dwordx4 v5, s[8:11], s40 offen lds
v_mfma_f32_32x32x16_bf16 v[64:79], v[124:127], v[136:139], v[64:79]
ds_read_b64_tr_b16 v[118:119], v9 offset:18432
ds_read_b128 v[132:135], v12 offset:4096
v_mfma_f32_32x32x16_bf16 v[96:111], v[124:127], v[140:143], v[96:111]
s_add_u32 m0, s39, 99328
s_mov_b32 s40, 8832
v_xor_b32 v6, 16, v5
buffer_load_dwordx4 v6, s[8:11], s40 offen lds
s_waitcnt lgkmcnt(0)
v_mfma_f32_32x32x16_bf16 v[48:63], v[112:115], v[128:131], v[48:63]
ds_read_b64_tr_b16 v[120:121], v8 offset:24576
ds_read_b64_tr_b16 v[122:123], v8 offset:26624
v_mfma_f32_32x32x16_bf16 v[80:95], v[112:115], v[132:135], v[80:95]
ds_read_b128 v[136:139], v13 offset:0
ds_read_b64_tr_b16 v[124:125], v9 offset:24576
v_mfma_f32_32x32x16_bf16 v[64:79], v[116:119], v[128:131], v[64:79]
ds_read_b64_tr_b16 v[126:127], v9 offset:26624
ds_read_b128 v[140:143], v13 offset:4096
v_mfma_f32_32x32x16_bf16 v[96:111], v[116:119], v[132:135], v[96:111]
s_waitcnt lgkmcnt(0)
s_waitcnt vmcnt(6)
s_barrier
v_add_u32 v8, 49152, v8
v_add_u32 v9, 49152, v9
v_add_u32 v10, 49152, v10
v_add_u32 v11, 49152, v11
v_add_u32 v12, 49152, v12
v_add_u32 v13, 49152, v13
v_mfma_f32_32x32x16_bf16 v[48:63], v[120:123], v[136:139], v[48:63]
ds_read_b64_tr_b16 v[112:113], v8 offset:0
ds_read_b64_tr_b16 v[114:115], v8 offset:2048
v_mfma_f32_32x32x16_bf16 v[80:95], v[120:123], v[140:143], v[80:95]
ds_read_b128 v[128:131], v10 offset:0
ds_read_b64_tr_b16 v[116:117], v9 offset:0
s_add_u32 m0, s37, 0
s_mul_i32 s40, s36, 6
s_add_u32 s40, s40, s32
buffer_load_dwordx4 v14, s[12:15], s40 offen lds
v_mfma_f32_32x32x16_bf16 v[64:79], v[124:127], v[136:139], v[64:79]
ds_read_b64_tr_b16 v[118:119], v9 offset:2048
ds_read_b128 v[132:135], v10 offset:4096
v_mfma_f32_32x32x16_bf16 v[96:111], v[124:127], v[140:143], v[96:111]
s_add_u32 m0, s37, 1024
s_mul_i32 s40, s36, 6
s_add_u32 s40, s40, s32
buffer_load_dwordx4 v15, s[12:15], s40 offen lds
s_waitcnt lgkmcnt(0)
v_mfma_f32_32x32x16_bf16 v[48:63], v[112:115], v[128:131], v[48:63]
ds_read_b64_tr_b16 v[120:121], v8 offset:8192
ds_read_b64_tr_b16 v[122:123], v8 offset:10240
v_mfma_f32_32x32x16_bf16 v[80:95], v[112:115], v[132:135], v[80:95]
ds_read_b128 v[136:139], v11 offset:0
ds_read_b64_tr_b16 v[124:125], v9 offset:8192
s_add_u32 m0, s37, 2048
s_mul_i32 s40, s36, 6
s_add_u32 s40, s40, s32
buffer_load_dwordx4 v16, s[12:15], s40 offen lds
v_mfma_f32_32x32x16_bf16 v[64:79], v[116:119], v[128:131], v[64:79]
ds_read_b64_tr_b16 v[126:127], v9 offset:10240
ds_read_b128 v[140:143], v11 offset:4096
v_mfma_f32_32x32x16_bf16 v[96:111], v[116:119], v[132:135], v[96:111]
s_add_u32 m0, s37, 3072
s_mul_i32 s40, s36, 6
s_add_u32 s40, s40, s32
buffer_load_dwordx4 v17, s[12:15], s40 offen lds
s_waitcnt lgkmcnt(0)
v_mfma_f32_32x32x16_bf16 v[48:63], v[120:123], v[136:139], v[48:63]
ds_read_b64_tr_b16 v[112:113], v8 offset:16384
ds_read_b64_tr_b16 v[114:115], v8 offset:18432
v_mfma_f32_32x32x16_bf16 v[80:95], v[120:123], v[140:143], v[80:95]
ds_read_b128 v[128:131], v12 offset:0
ds_read_b64_tr_b16 v[116:117], v9 offset:16384
s_add_u32 m0, s39, 0
s_mov_b32 s40, 768
buffer_load_dwordx4 v5, s[8:11], s40 offen lds
v_mfma_f32_32x32x16_bf16 v[64:79], v[124:127], v[136:139], v[64:79]
ds_read_b64_tr_b16 v[118:119], v9 offset:18432
ds_read_b128 v[132:135], v12 offset:4096
v_mfma_f32_32x32x16_bf16 v[96:111], v[124:127], v[140:143], v[96:111]
s_add_u32 m0, s39, 1024
s_mov_b32 s40, 8960
v_xor_b32 v6, 16, v5
buffer_load_dwordx4 v6, s[8:11], s40 offen lds
s_waitcnt lgkmcnt(0)
v_mfma_f32_32x32x16_bf16 v[48:63], v[112:115], v[128:131], v[48:63]
ds_read_b64_tr_b16 v[120:121], v8 offset:24576
ds_read_b64_tr_b16 v[122:123], v8 offset:26624
v_mfma_f32_32x32x16_bf16 v[80:95], v[112:115], v[132:135], v[80:95]
ds_read_b128 v[136:139], v13 offset:0
ds_read_b64_tr_b16 v[124:125], v9 offset:24576
v_mfma_f32_32x32x16_bf16 v[64:79], v[116:119], v[128:131], v[64:79]
ds_read_b64_tr_b16 v[126:127], v9 offset:26624
ds_read_b128 v[140:143], v13 offset:4096
v_mfma_f32_32x32x16_bf16 v[96:111], v[116:119], v[132:135], v[96:111]
s_waitcnt lgkmcnt(0)
s_waitcnt vmcnt(6)
s_barrier
v_add_u32 v8, 49152, v8
v_add_u32 v9, 49152, v9
v_add_u32 v10, 49152, v10
v_add_u32 v11, 49152, v11
v_add_u32 v12, 49152, v12
v_add_u32 v13, 49152, v13
v_mfma_f32_32x32x16_bf16 v[48:63], v[120:123], v[136:139], v[48:63]
ds_read_b64_tr_b16 v[112:113], v8 offset:0
ds_read_b64_tr_b16 v[114:115], v8 offset:2048
v_mfma_f32_32x32x16_bf16 v[80:95], v[120:123], v[140:143], v[80:95]
ds_read_b128 v[128:131], v10 offset:0
ds_read_b64_tr_b16 v[116:117], v9 offset:0
s_add_u32 m0, s37, 49152
s_mul_i32 s40, s36, 7
s_add_u32 s40, s40, s32
buffer_load_dwordx4 v14, s[12:15], s40 offen lds
v_mfma_f32_32x32x16_bf16 v[64:79], v[124:127], v[136:139], v[64:79]
ds_read_b64_tr_b16 v[118:119], v9 offset:2048
ds_read_b128 v[132:135], v10 offset:4096
v_mfma_f32_32x32x16_bf16 v[96:111], v[124:127], v[140:143], v[96:111]
s_add_u32 m0, s37, 50176
s_mul_i32 s40, s36, 7
s_add_u32 s40, s40, s32
buffer_load_dwordx4 v15, s[12:15], s40 offen lds
s_waitcnt lgkmcnt(0)
v_mfma_f32_32x32x16_bf16 v[48:63], v[112:115], v[128:131], v[48:63]
ds_read_b64_tr_b16 v[120:121], v8 offset:8192
ds_read_b64_tr_b16 v[122:123], v8 offset:10240
v_mfma_f32_32x32x16_bf16 v[80:95], v[112:115], v[132:135], v[80:95]
ds_read_b128 v[136:139], v11 offset:0
ds_read_b64_tr_b16 v[124:125], v9 offset:8192
s_add_u32 m0, s37, 51200
s_mul_i32 s40, s36, 7
s_add_u32 s40, s40, s32
buffer_load_dwordx4 v16, s[12:15], s40 offen lds
v_mfma_f32_32x32x16_bf16 v[64:79], v[116:119], v[128:131], v[64:79]
ds_read_b64_tr_b16 v[126:127], v9 offset:10240
ds_read_b128 v[140:143], v11 offset:4096
v_mfma_f32_32x32x16_bf16 v[96:111], v[116:119], v[132:135], v[96:111]
s_add_u32 m0, s37, 52224
s_mul_i32 s40, s36, 7
s_add_u32 s40, s40, s32
buffer_load_dwordx4 v17, s[12:15], s40 offen lds
s_waitcnt lgkmcnt(0)
v_mfma_f32_32x32x16_bf16 v[48:63], v[120:123], v[136:139], v[48:63]
ds_read_b64_tr_b16 v[112:113], v8 offset:16384
ds_read_b64_tr_b16 v[114:115], v8 offset:18432
v_mfma_f32_32x32x16_bf16 v[80:95], v[120:123], v[140:143], v[80:95]
ds_read_b128 v[128:131], v12 offset:0
ds_read_b64_tr_b16 v[116:117], v9 offset:16384
s_add_u32 m0, s39, 49152
s_mov_b32 s40, 896
buffer_load_dwordx4 v5, s[8:11], s40 offen lds
v_mfma_f32_32x32x16_bf16 v[64:79], v[124:127], v[136:139], v[64:79]
ds_read_b64_tr_b16 v[118:119], v9 offset:18432
ds_read_b128 v[132:135], v12 offset:4096
v_mfma_f32_32x32x16_bf16 v[96:111], v[124:127], v[140:143], v[96:111]
s_add_u32 m0, s39, 50176
s_mov_b32 s40, 9088
v_xor_b32 v6, 16, v5
buffer_load_dwordx4 v6, s[8:11], s40 offen lds
s_waitcnt lgkmcnt(0)
v_mfma_f32_32x32x16_bf16 v[48:63], v[112:115], v[128:131], v[48:63]
ds_read_b64_tr_b16 v[120:121], v8 offset:24576
ds_read_b64_tr_b16 v[122:123], v8 offset:26624
v_mfma_f32_32x32x16_bf16 v[80:95], v[112:115], v[132:135], v[80:95]
ds_read_b128 v[136:139], v13 offset:0
ds_read_b64_tr_b16 v[124:125], v9 offset:24576
v_mfma_f32_32x32x16_bf16 v[64:79], v[116:119], v[128:131], v[64:79]
ds_read_b64_tr_b16 v[126:127], v9 offset:26624
ds_read_b128 v[140:143], v13 offset:4096
v_mfma_f32_32x32x16_bf16 v[96:111], v[116:119], v[132:135], v[96:111]
s_waitcnt lgkmcnt(0)
s_waitcnt vmcnt(6)
s_barrier
v_add_u32 v8, 0xfffe8000, v8
v_add_u32 v9, 0xfffe8000, v9
v_add_u32 v10, 0xfffe8000, v10
v_add_u32 v11, 0xfffe8000, v11
v_add_u32 v12, 0xfffe8000, v12
v_add_u32 v13, 0xfffe8000, v13
v_mfma_f32_32x32x16_bf16 v[48:63], v[120:123], v[136:139], v[48:63]
ds_read_b64_tr_b16 v[112:113], v8 offset:0
ds_read_b64_tr_b16 v[114:115], v8 offset:2048
v_mfma_f32_32x32x16_bf16 v[80:95], v[120:123], v[140:143], v[80:95]
ds_read_b128 v[128:131], v10 offset:0
ds_read_b64_tr_b16 v[116:117], v9 offset:0
v_mfma_f32_32x32x16_bf16 v[64:79], v[124:127], v[136:139], v[64:79]
ds_read_b64_tr_b16 v[118:119], v9 offset:2048
ds_read_b128 v[132:135], v10 offset:4096
v_mfma_f32_32x32x16_bf16 v[96:111], v[124:127], v[140:143], v[96:111]
s_waitcnt lgkmcnt(0)
v_mfma_f32_32x32x16_bf16 v[48:63], v[112:115], v[128:131], v[48:63]
ds_read_b64_tr_b16 v[120:121], v8 offset:8192
ds_read_b64_tr_b16 v[122:123], v8 offset:10240
v_mfma_f32_32x32x16_bf16 v[80:95], v[112:115], v[132:135], v[80:95]
ds_read_b128 v[136:139], v11 offset:0
ds_read_b64_tr_b16 v[124:125], v9 offset:8192
v_mfma_f32_32x32x16_bf16 v[64:79], v[116:119], v[128:131], v[64:79]
ds_read_b64_tr_b16 v[126:127], v9 offset:10240
ds_read_b128 v[140:143], v11 offset:4096
v_mfma_f32_32x32x16_bf16 v[96:111], v[116:119], v[132:135], v[96:111]
s_waitcnt lgkmcnt(0)
v_mfma_f32_32x32x16_bf16 v[48:63], v[120:123], v[136:139], v[48:63]
ds_read_b64_tr_b16 v[112:113], v8 offset:16384
ds_read_b64_tr_b16 v[114:115], v8 offset:18432
v_mfma_f32_32x32x16_bf16 v[80:95], v[120:123], v[140:143], v[80:95]
ds_read_b128 v[128:131], v12 offset:0
ds_read_b64_tr_b16 v[116:117], v9 offset:16384
v_mfma_f32_32x32x16_bf16 v[64:79], v[124:127], v[136:139], v[64:79]
ds_read_b64_tr_b16 v[118:119], v9 offset:18432
ds_read_b128 v[132:135], v12 offset:4096
v_mfma_f32_32x32x16_bf16 v[96:111], v[124:127], v[140:143], v[96:111]
s_waitcnt lgkmcnt(0)
v_mfma_f32_32x32x16_bf16 v[48:63], v[112:115], v[128:131], v[48:63]
ds_read_b64_tr_b16 v[120:121], v8 offset:24576
ds_read_b64_tr_b16 v[122:123], v8 offset:26624
v_mfma_f32_32x32x16_bf16 v[80:95], v[112:115], v[132:135], v[80:95]
ds_read_b128 v[136:139], v13 offset:0
ds_read_b64_tr_b16 v[124:125], v9 offset:24576
v_mfma_f32_32x32x16_bf16 v[64:79], v[116:119], v[128:131], v[64:79]
ds_read_b64_tr_b16 v[126:127], v9 offset:26624
ds_read_b128 v[140:143], v13 offset:4096
v_mfma_f32_32x32x16_bf16 v[96:111], v[116:119], v[132:135], v[96:111]
s_waitcnt lgkmcnt(0)
s_waitcnt vmcnt(0)
s_barrier
v_add_u32 v8, 49152, v8
v_add_u32 v9, 49152, v9
v_add_u32 v10, 49152, v10
v_add_u32 v11, 49152, v11
v_add_u32 v12, 49152, v12
v_add_u32 v13, 49152, v13
v_mfma_f32_32x32x16_bf16 v[48:63], v[120:123], v[136:139], v[48:63]
ds_read_b64_tr_b16 v[112:113], v8 offset:0
ds_read_b64_tr_b16 v[114:115], v8 offset:2048
v_mfma_f32_32x32x16_bf16 v[80:95], v[120:123], v[140:143], v[80:95]
ds_read_b128 v[128:131], v10 offset:0
ds_read_b64_tr_b16 v[116:117], v9 offset:0
v_mfma_f32_32x32x16_bf16 v[64:79], v[124:127], v[136:139], v[64:79]
ds_read_b64_tr_b16 v[118:119], v9 offset:2048
ds_read_b128 v[132:135], v10 offset:4096
v_mfma_f32_32x32x16_bf16 v[96:111], v[124:127], v[140:143], v[96:111]
s_waitcnt lgkmcnt(0)
v_mfma_f32_32x32x16_bf16 v[48:63], v[112:115], v[128:131], v[48:63]
ds_read_b64_tr_b16 v[120:121], v8 offset:8192
ds_read_b64_tr_b16 v[122:123], v8 offset:10240
v_mfma_f32_32x32x16_bf16 v[80:95], v[112:115], v[132:135], v[80:95]
ds_read_b128 v[136:139], v11 offset:0
ds_read_b64_tr_b16 v[124:125], v9 offset:8192
v_mfma_f32_32x32x16_bf16 v[64:79], v[116:119], v[128:131], v[64:79]
ds_read_b64_tr_b16 v[126:127], v9 offset:10240
ds_read_b128 v[140:143], v11 offset:4096
v_mfma_f32_32x32x16_bf16 v[96:111], v[116:119], v[132:135], v[96:111]
s_waitcnt lgkmcnt(0)
v_mfma_f32_32x32x16_bf16 v[48:63], v[120:123], v[136:139], v[48:63]
ds_read_b64_tr_b16 v[112:113], v8 offset:16384
ds_read_b64_tr_b16 v[114:115], v8 offset:18432
v_mfma_f32_32x32x16_bf16 v[80:95], v[120:123], v[140:143], v[80:95]
ds_read_b128 v[128:131], v12 offset:0
ds_read_b64_tr_b16 v[116:117], v9 offset:16384
v_mfma_f32_32x32x16_bf16 v[64:79], v[124:127], v[136:139], v[64:79]
ds_read_b64_tr_b16 v[118:119], v9 offset:18432
ds_read_b128 v[132:135], v12 offset:4096
v_mfma_f32_32x32x16_bf16 v[96:111], v[124:127], v[140:143], v[96:111]
s_waitcnt lgkmcnt(0)
v_mfma_f32_32x32x16_bf16 v[48:63], v[112:115], v[128:131], v[48:63]
ds_read_b64_tr_b16 v[120:121], v8 offset:24576
ds_read_b64_tr_b16 v[122:123], v8 offset:26624
v_mfma_f32_32x32x16_bf16 v[80:95], v[112:115], v[132:135], v[80:95]
ds_read_b128 v[136:139], v13 offset:0
ds_read_b64_tr_b16 v[124:125], v9 offset:24576
v_mfma_f32_32x32x16_bf16 v[64:79], v[116:119], v[128:131], v[64:79]
ds_read_b64_tr_b16 v[126:127], v9 offset:26624
ds_read_b128 v[140:143], v13 offset:4096
v_mfma_f32_32x32x16_bf16 v[96:111], v[116:119], v[132:135], v[96:111]
s_waitcnt lgkmcnt(0)
v_mfma_f32_32x32x16_bf16 v[48:63], v[120:123], v[136:139], v[48:63]
v_mfma_f32_32x32x16_bf16 v[80:95], v[120:123], v[140:143], v[80:95]
v_mfma_f32_32x32x16_bf16 v[64:79], v[124:127], v[136:139], v[64:79]
v_mfma_f32_32x32x16_bf16 v[96:111], v[124:127], v[140:143], v[96:111]

v_and_b32 v3, 31, v1
s_lshl_b32 s40, s29, 6
s_add_u32 s38, s38, s40
v_add_u32 v3, s38, v3
v_lshrrev_b32 v4, 5, v1

s_cmp_ge_u32 s26, 6
s_cbranch_scc1 K1_EPI_H
s_cmp_lt_u32 s26, 2
s_cselect_b32 s44, 0x3eb8aa3b, 1.0
s_lshr_b32 s45, s26, 1
s_lshl_b32 s45, s45, 21
s_and_b32 s46, s26, 1
s_lshl_b32 s46, s46, 4
s_lshl_b32 s47, s30, 2
s_add_u32 s46, s46, s47
s_lshl_b32 s46, s46, 16
s_add_u32 s45, s45, s46
s_cmp_lt_u32 s26, 4
s_cbranch_scc0 K1_EPI_V
v_lshlrev_b32 v40, 4, v3
v_lshl_add_u32 v40, v4, 3, v40
v_add_u32 v41, 512, v40
s_mov_b32 s47, 32768
s_branch K1_EPI_QKV
K1_EPI_V:
v_lshlrev_b32 v40, 5, v3
v_lshl_add_u32 v40, v4, 3, v40
v_add_u32 v41, 1024, v40
s_mov_b32 s47, 16
K1_EPI_QKV:
v_mov_b32 v2, s47
v_mul_lo_u32 v2, v2, v4
v_lshlrev_b32 v6, 3, v4
v_sub_u32 v2, v2, v6
v_add_u32 v40, v40, v2
v_add_u32 v41, v41, v2
s_add_u32 s46, s45, 0
v_mul_f32 v48, s44, v48
v_mul_f32 v49, s44, v49
v_mul_f32 v50, s44, v50
v_mul_f32 v51, s44, v51
v_mul_f32 v52, s44, v52
v_mul_f32 v53, s44, v53
v_mul_f32 v54, s44, v54
v_mul_f32 v55, s44, v55
v_cvt_pk_bf16_f32 v48, v48, v49
v_cvt_pk_bf16_f32 v49, v50, v51
v_cvt_pk_bf16_f32 v50, v52, v53
v_cvt_pk_bf16_f32 v51, v54, v55
s_nop 1
v_permlane32_swap_b32 v48, v50
v_permlane32_swap_b32 v49, v51
s_nop 0
buffer_store_dwordx4 v[48:51], v40, s[16:19], s46 offen
v_mul_f32 v80, s44, v80
v_mul_f32 v81, s44, v81
v_mul_f32 v82, s44, v82
v_mul_f32 v83, s44, v83
v_mul_f32 v84, s44, v84
v_mul_f32 v85, s44, v85
v_mul_f32 v86, s44, v86
v_mul_f32 v87, s44, v87
v_cvt_pk_bf16_f32 v80, v80, v81
v_cvt_pk_bf16_f32 v81, v82, v83
v_cvt_pk_bf16_f32 v82, v84, v85
v_cvt_pk_bf16_f32 v83, v86, v87
s_nop 1
v_permlane32_swap_b32 v80, v82
v_permlane32_swap_b32 v81, v83
s_nop 0
buffer_store_dwordx4 v[80:83], v41, s[16:19], s46 offen
s_add_u32 s46, s45, 65536
v_mul_f32 v56, s44, v56
v_mul_f32 v57, s44, v57
v_mul_f32 v58, s44, v58
v_mul_f32 v59, s44, v59
v_mul_f32 v60, s44, v60
v_mul_f32 v61, s44, v61
v_mul_f32 v62, s44, v62
v_mul_f32 v63, s44, v63
v_cvt_pk_bf16_f32 v56, v56, v57
v_cvt_pk_bf16_f32 v57, v58, v59
v_cvt_pk_bf16_f32 v58, v60, v61
v_cvt_pk_bf16_f32 v59, v62, v63
s_nop 1
v_permlane32_swap_b32 v56, v58
v_permlane32_swap_b32 v57, v59
s_nop 0
buffer_store_dwordx4 v[56:59], v40, s[16:19], s46 offen
v_mul_f32 v88, s44, v88
v_mul_f32 v89, s44, v89
v_mul_f32 v90, s44, v90
v_mul_f32 v91, s44, v91
v_mul_f32 v92, s44, v92
v_mul_f32 v93, s44, v93
v_mul_f32 v94, s44, v94
v_mul_f32 v95, s44, v95
v_cvt_pk_bf16_f32 v88, v88, v89
v_cvt_pk_bf16_f32 v89, v90, v91
v_cvt_pk_bf16_f32 v90, v92, v93
v_cvt_pk_bf16_f32 v91, v94, v95
s_nop 1
v_permlane32_swap_b32 v88, v90
v_permlane32_swap_b32 v89, v91
s_nop 0
buffer_store_dwordx4 v[88:91], v41, s[16:19], s46 offen
s_add_u32 s46, s45, 131072
v_mul_f32 v64, s44, v64
v_mul_f32 v65, s44, v65
v_mul_f32 v66, s44, v66
v_mul_f32 v67, s44, v67
v_mul_f32 v68, s44, v68
v_mul_f32 v69, s44, v69
v_mul_f32 v70, s44, v70
v_mul_f32 v71, s44, v71
v_cvt_pk_bf16_f32 v64, v64, v65
v_cvt_pk_bf16_f32 v65, v66, v67
v_cvt_pk_bf16_f32 v66, v68, v69
v_cvt_pk_bf16_f32 v67, v70, v71
s_nop 1
v_permlane32_swap_b32 v64, v66
v_permlane32_swap_b32 v65, v67
s_nop 0
buffer_store_dwordx4 v[64:67], v40, s[16:19], s46 offen
v_mul_f32 v96, s44, v96
v_mul_f32 v97, s44, v97
v_mul_f32 v98, s44, v98
v_mul_f32 v99, s44, v99
v_mul_f32 v100, s44, v100
v_mul_f32 v101, s44, v101
v_mul_f32 v102, s44, v102
v_mul_f32 v103, s44, v103
v_cvt_pk_bf16_f32 v96, v96, v97
v_cvt_pk_bf16_f32 v97, v98, v99
v_cvt_pk_bf16_f32 v98, v100, v101
v_cvt_pk_bf16_f32 v99, v102, v103
s_nop 1
v_permlane32_swap_b32 v96, v98
v_permlane32_swap_b32 v97, v99
s_nop 0
buffer_store_dwordx4 v[96:99], v41, s[16:19], s46 offen
s_add_u32 s46, s45, 196608
v_mul_f32 v72, s44, v72
v_mul_f32 v73, s44, v73
v_mul_f32 v74, s44, v74
v_mul_f32 v75, s44, v75
v_mul_f32 v76, s44, v76
v_mul_f32 v77, s44, v77
v_mul_f32 v78, s44, v78
v_mul_f32 v79, s44, v79
v_cvt_pk_bf16_f32 v72, v72, v73
v_cvt_pk_bf16_f32 v73, v74, v75
v_cvt_pk_bf16_f32 v74, v76, v77
v_cvt_pk_bf16_f32 v75, v78, v79
s_nop 1
v_permlane32_swap_b32 v72, v74
v_permlane32_swap_b32 v73, v75
s_nop 0
buffer_store_dwordx4 v[72:75], v40, s[16:19], s46 offen
v_mul_f32 v104, s44, v104
v_mul_f32 v105, s44, v105
v_mul_f32 v106, s44, v106
v_mul_f32 v107, s44, v107
v_mul_f32 v108, s44, v108
v_mul_f32 v109, s44, v109
v_mul_f32 v110, s44, v110
v_mul_f32 v111, s44, v111
v_cvt_pk_bf16_f32 v104, v104, v105
v_cvt_pk_bf16_f32 v105, v106, v107
v_cvt_pk_bf16_f32 v106, v108, v109
v_cvt_pk_bf16_f32 v107, v110, v111
s_nop 1
v_permlane32_swap_b32 v104, v106
v_permlane32_swap_b32 v105, v107
s_nop 0
buffer_store_dwordx4 v[104:107], v41, s[16:19], s46 offen
s_branch K1_DONE
K1_EPI_H:
s_mov_b32 s46, 4608
v_mul_lo_u32 v40, v3, s46
v_lshl_add_u32 v40, v4, 3, v40
v_add_u32 v41, 147456, v40
s_add_u32 s47, s45, 6292480
v_mov_b32 v6, 0xc0135761
s_waitcnt vmcnt(0)
s_nop 0
v_lshlrev_b32 v2, 3, v4
v_add_u32 v40, v40, v2
v_add_u32 v41, v41, v2
v_lshlrev_b32 v32, 16, v144
v_and_b32 v33, 0xffff0000, v144
v_lshlrev_b32 v34, 16, v145
v_and_b32 v35, 0xffff0000, v145
v_add_f32 v48, v48, v32
v_add_f32 v49, v49, v33
v_add_f32 v50, v50, v34
v_add_f32 v51, v51, v35
v_mul_f32 v24, v48, v48
v_mul_f32 v25, v49, v49
v_mul_f32 v26, v50, v50
v_mul_f32 v27, v51, v51
v_fmamk_f32 v24, v24, 0xbdd2d3e8, v6
v_fmamk_f32 v25, v25, 0xbdd2d3e8, v6
v_fmamk_f32 v26, v26, 0xbdd2d3e8, v6
v_fmamk_f32 v27, v27, 0xbdd2d3e8, v6
v_mul_f32 v24, v24, v48
v_mul_f32 v25, v25, v49
v_mul_f32 v26, v26, v50
v_mul_f32 v27, v27, v51
v_exp_f32 v24, v24
v_exp_f32 v25, v25
v_exp_f32 v26, v26
v_exp_f32 v27, v27
v_add_f32 v24, 1.0, v24
v_add_f32 v25, 1.0, v25
v_add_f32 v26, 1.0, v26
v_add_f32 v27, 1.0, v27
v_rcp_f32 v24, v24
v_rcp_f32 v25, v25
v_rcp_f32 v26, v26
v_rcp_f32 v27, v27
v_mul_f32 v48, v48, v24
v_mul_f32 v49, v49, v25
v_mul_f32 v50, v50, v26
v_mul_f32 v51, v51, v27
v_cvt_pk_bf16_f32 v36, v48, v49
v_cvt_pk_bf16_f32 v37, v50, v51
v_mov_b32 v48, v36
v_mov_b32 v49, v37
v_add_f32 v80, v80, v32
v_add_f32 v81, v81, v33
v_add_f32 v82, v82, v34
v_add_f32 v83, v83, v35
v_mul_f32 v28, v80, v80
v_mul_f32 v29, v81, v81
v_mul_f32 v30, v82, v82
v_mul_f32 v31, v83, v83
v_fmamk_f32 v28, v28, 0xbdd2d3e8, v6
v_fmamk_f32 v29, v29, 0xbdd2d3e8, v6
v_fmamk_f32 v30, v30, 0xbdd2d3e8, v6
v_fmamk_f32 v31, v31, 0xbdd2d3e8, v6
v_mul_f32 v28, v28, v80
v_mul_f32 v29, v29, v81
v_mul_f32 v30, v30, v82
v_mul_f32 v31, v31, v83
v_exp_f32 v28, v28
v_exp_f32 v29, v29
v_exp_f32 v30, v30
v_exp_f32 v31, v31
v_add_f32 v28, 1.0, v28
v_add_f32 v29, 1.0, v29
v_add_f32 v30, 1.0, v30
v_add_f32 v31, 1.0, v31
v_rcp_f32 v28, v28
v_rcp_f32 v29, v29
v_rcp_f32 v30, v30
v_rcp_f32 v31, v31
v_mul_f32 v80, v80, v28
v_mul_f32 v81, v81, v29
v_mul_f32 v82, v82, v30
v_mul_f32 v83, v83, v31
v_cvt_pk_bf16_f32 v38, v80, v81
v_cvt_pk_bf16_f32 v39, v82, v83
v_mov_b32 v80, v38
v_mov_b32 v81, v39
v_lshlrev_b32 v32, 16, v146
v_and_b32 v33, 0xffff0000, v146
v_lshlrev_b32 v34, 16, v147
v_and_b32 v35, 0xffff0000, v147
v_add_f32 v52, v52, v32
v_add_f32 v53, v53, v33
v_add_f32 v54, v54, v34
v_add_f32 v55, v55, v35
v_mul_f32 v24, v52, v52
v_mul_f32 v25, v53, v53
v_mul_f32 v26, v54, v54
v_mul_f32 v27, v55, v55
v_fmamk_f32 v24, v24, 0xbdd2d3e8, v6
v_fmamk_f32 v25, v25, 0xbdd2d3e8, v6
v_fmamk_f32 v26, v26, 0xbdd2d3e8, v6
v_fmamk_f32 v27, v27, 0xbdd2d3e8, v6
v_mul_f32 v24, v24, v52
v_mul_f32 v25, v25, v53
v_mul_f32 v26, v26, v54
v_mul_f32 v27, v27, v55
v_exp_f32 v24, v24
v_exp_f32 v25, v25
v_exp_f32 v26, v26
v_exp_f32 v27, v27
v_add_f32 v24, 1.0, v24
v_add_f32 v25, 1.0, v25
v_add_f32 v26, 1.0, v26
v_add_f32 v27, 1.0, v27
v_rcp_f32 v24, v24
v_rcp_f32 v25, v25
v_rcp_f32 v26, v26
v_rcp_f32 v27, v27
v_mul_f32 v52, v52, v24
v_mul_f32 v53, v53, v25
v_mul_f32 v54, v54, v26
v_mul_f32 v55, v55, v27
v_cvt_pk_bf16_f32 v36, v52, v53
v_cvt_pk_bf16_f32 v37, v54, v55
v_mov_b32 v50, v36
v_mov_b32 v51, v37
s_nop 1
v_permlane32_swap_b32 v48, v50
v_permlane32_swap_b32 v49, v51
s_nop 0
buffer_store_dwordx4 v[48:51], v40, s[16:19], s47 offen offset:0
v_add_f32 v84, v84, v32
v_add_f32 v85, v85, v33
v_add_f32 v86, v86, v34
v_add_f32 v87, v87, v35
v_mul_f32 v28, v84, v84
v_mul_f32 v29, v85, v85
v_mul_f32 v30, v86, v86
v_mul_f32 v31, v87, v87
v_fmamk_f32 v28, v28, 0xbdd2d3e8, v6
v_fmamk_f32 v29, v29, 0xbdd2d3e8, v6
v_fmamk_f32 v30, v30, 0xbdd2d3e8, v6
v_fmamk_f32 v31, v31, 0xbdd2d3e8, v6
v_mul_f32 v28, v28, v84
v_mul_f32 v29, v29, v85
v_mul_f32 v30, v30, v86
v_mul_f32 v31, v31, v87
v_exp_f32 v28, v28
v_exp_f32 v29, v29
v_exp_f32 v30, v30
v_exp_f32 v31, v31
v_add_f32 v28, 1.0, v28
v_add_f32 v29, 1.0, v29
v_add_f32 v30, 1.0, v30
v_add_f32 v31, 1.0, v31
v_rcp_f32 v28, v28
v_rcp_f32 v29, v29
v_rcp_f32 v30, v30
v_rcp_f32 v31, v31
v_mul_f32 v84, v84, v28
v_mul_f32 v85, v85, v29
v_mul_f32 v86, v86, v30
v_mul_f32 v87, v87, v31
v_cvt_pk_bf16_f32 v38, v84, v85
v_cvt_pk_bf16_f32 v39, v86, v87
v_mov_b32 v82, v38
v_mov_b32 v83, v39
s_nop 1
v_permlane32_swap_b32 v80, v82
v_permlane32_swap_b32 v81, v83
s_nop 0
buffer_store_dwordx4 v[80:83], v41, s[16:19], s47 offen offset:0
v_lshlrev_b32 v32, 16, v148
v_and_b32 v33, 0xffff0000, v148
v_lshlrev_b32 v34, 16, v149
v_and_b32 v35, 0xffff0000, v149
v_add_f32 v56, v56, v32
v_add_f32 v57, v57, v33
v_add_f32 v58, v58, v34
v_add_f32 v59, v59, v35
v_mul_f32 v24, v56, v56
v_mul_f32 v25, v57, v57
v_mul_f32 v26, v58, v58
v_mul_f32 v27, v59, v59
v_fmamk_f32 v24, v24, 0xbdd2d3e8, v6
v_fmamk_f32 v25, v25, 0xbdd2d3e8, v6
v_fmamk_f32 v26, v26, 0xbdd2d3e8, v6
v_fmamk_f32 v27, v27, 0xbdd2d3e8, v6
v_mul_f32 v24, v24, v56
v_mul_f32 v25, v25, v57
v_mul_f32 v26, v26, v58
v_mul_f32 v27, v27, v59
v_exp_f32 v24, v24
v_exp_f32 v25, v25
v_exp_f32 v26, v26
v_exp_f32 v27, v27
v_add_f32 v24, 1.0, v24
v_add_f32 v25, 1.0, v25
v_add_f32 v26, 1.0, v26
v_add_f32 v27, 1.0, v27
v_rcp_f32 v24, v24
v_rcp_f32 v25, v25
v_rcp_f32 v26, v26
v_rcp_f32 v27, v27
v_mul_f32 v56, v56, v24
v_mul_f32 v57, v57, v25
v_mul_f32 v58, v58, v26
v_mul_f32 v59, v59, v27
v_cvt_pk_bf16_f32 v36, v56, v57
v_cvt_pk_bf16_f32 v37, v58, v59
v_mov_b32 v56, v36
v_mov_b32 v57, v37
v_add_f32 v88, v88, v32
v_add_f32 v89, v89, v33
v_add_f32 v90, v90, v34
v_add_f32 v91, v91, v35
v_mul_f32 v28, v88, v88
v_mul_f32 v29, v89, v89
v_mul_f32 v30, v90, v90
v_mul_f32 v31, v91, v91
v_fmamk_f32 v28, v28, 0xbdd2d3e8, v6
v_fmamk_f32 v29, v29, 0xbdd2d3e8, v6
v_fmamk_f32 v30, v30, 0xbdd2d3e8, v6
v_fmamk_f32 v31, v31, 0xbdd2d3e8, v6
v_mul_f32 v28, v28, v88
v_mul_f32 v29, v29, v89
v_mul_f32 v30, v30, v90
v_mul_f32 v31, v31, v91
v_exp_f32 v28, v28
v_exp_f32 v29, v29
v_exp_f32 v30, v30
v_exp_f32 v31, v31
v_add_f32 v28, 1.0, v28
v_add_f32 v29, 1.0, v29
v_add_f32 v30, 1.0, v30
v_add_f32 v31, 1.0, v31
v_rcp_f32 v28, v28
v_rcp_f32 v29, v29
v_rcp_f32 v30, v30
v_rcp_f32 v31, v31
v_mul_f32 v88, v88, v28
v_mul_f32 v89, v89, v29
v_mul_f32 v90, v90, v30
v_mul_f32 v91, v91, v31
v_cvt_pk_bf16_f32 v38, v88, v89
v_cvt_pk_bf16_f32 v39, v90, v91
v_mov_b32 v88, v38
v_mov_b32 v89, v39
v_lshlrev_b32 v32, 16, v150
v_and_b32 v33, 0xffff0000, v150
v_lshlrev_b32 v34, 16, v151
v_and_b32 v35, 0xffff0000, v151
v_add_f32 v60, v60, v32
v_add_f32 v61, v61, v33
v_add_f32 v62, v62, v34
v_add_f32 v63, v63, v35
v_mul_f32 v24, v60, v60
v_mul_f32 v25, v61, v61
v_mul_f32 v26, v62, v62
v_mul_f32 v27, v63, v63
v_fmamk_f32 v24, v24, 0xbdd2d3e8, v6
v_fmamk_f32 v25, v25, 0xbdd2d3e8, v6
v_fmamk_f32 v26, v26, 0xbdd2d3e8, v6
v_fmamk_f32 v27, v27, 0xbdd2d3e8, v6
v_mul_f32 v24, v24, v60
v_mul_f32 v25, v25, v61
v_mul_f32 v26, v26, v62
v_mul_f32 v27, v27, v63
v_exp_f32 v24, v24
v_exp_f32 v25, v25
v_exp_f32 v26, v26
v_exp_f32 v27, v27
v_add_f32 v24, 1.0, v24
v_add_f32 v25, 1.0, v25
v_add_f32 v26, 1.0, v26
v_add_f32 v27, 1.0, v27
v_rcp_f32 v24, v24
v_rcp_f32 v25, v25
v_rcp_f32 v26, v26
v_rcp_f32 v27, v27
v_mul_f32 v60, v60, v24
v_mul_f32 v61, v61, v25
v_mul_f32 v62, v62, v26
v_mul_f32 v63, v63, v27
v_cvt_pk_bf16_f32 v36, v60, v61
v_cvt_pk_bf16_f32 v37, v62, v63
v_mov_b32 v58, v36
v_mov_b32 v59, v37
s_nop 1
v_permlane32_swap_b32 v56, v58
v_permlane32_swap_b32 v57, v59
s_nop 0
buffer_store_dwordx4 v[56:59], v40, s[16:19], s47 offen offset:32
v_add_f32 v92, v92, v32
v_add_f32 v93, v93, v33
v_add_f32 v94, v94, v34
v_add_f32 v95, v95, v35
v_mul_f32 v28, v92, v92
v_mul_f32 v29, v93, v93
v_mul_f32 v30, v94, v94
v_mul_f32 v31, v95, v95
v_fmamk_f32 v28, v28, 0xbdd2d3e8, v6
v_fmamk_f32 v29, v29, 0xbdd2d3e8, v6
v_fmamk_f32 v30, v30, 0xbdd2d3e8, v6
v_fmamk_f32 v31, v31, 0xbdd2d3e8, v6
v_mul_f32 v28, v28, v92
v_mul_f32 v29, v29, v93
v_mul_f32 v30, v30, v94
v_mul_f32 v31, v31, v95
v_exp_f32 v28, v28
v_exp_f32 v29, v29
v_exp_f32 v30, v30
v_exp_f32 v31, v31
v_add_f32 v28, 1.0, v28
v_add_f32 v29, 1.0, v29
v_add_f32 v30, 1.0, v30
v_add_f32 v31, 1.0, v31
v_rcp_f32 v28, v28
v_rcp_f32 v29, v29
v_rcp_f32 v30, v30
v_rcp_f32 v31, v31
v_mul_f32 v92, v92, v28
v_mul_f32 v93, v93, v29
v_mul_f32 v94, v94, v30
v_mul_f32 v95, v95, v31
v_cvt_pk_bf16_f32 v38, v92, v93
v_cvt_pk_bf16_f32 v39, v94, v95
v_mov_b32 v90, v38
v_mov_b32 v91, v39
s_nop 1
v_permlane32_swap_b32 v88, v90
v_permlane32_swap_b32 v89, v91
s_nop 0
buffer_store_dwordx4 v[88:91], v41, s[16:19], s47 offen offset:32
v_lshlrev_b32 v32, 16, v152
v_and_b32 v33, 0xffff0000, v152
v_lshlrev_b32 v34, 16, v153
v_and_b32 v35, 0xffff0000, v153
v_add_f32 v64, v64, v32
v_add_f32 v65, v65, v33
v_add_f32 v66, v66, v34
v_add_f32 v67, v67, v35
v_mul_f32 v24, v64, v64
v_mul_f32 v25, v65, v65
v_mul_f32 v26, v66, v66
v_mul_f32 v27, v67, v67
v_fmamk_f32 v24, v24, 0xbdd2d3e8, v6
v_fmamk_f32 v25, v25, 0xbdd2d3e8, v6
v_fmamk_f32 v26, v26, 0xbdd2d3e8, v6
v_fmamk_f32 v27, v27, 0xbdd2d3e8, v6
v_mul_f32 v24, v24, v64
v_mul_f32 v25, v25, v65
v_mul_f32 v26, v26, v66
v_mul_f32 v27, v27, v67
v_exp_f32 v24, v24
v_exp_f32 v25, v25
v_exp_f32 v26, v26
v_exp_f32 v27, v27
v_add_f32 v24, 1.0, v24
v_add_f32 v25, 1.0, v25
v_add_f32 v26, 1.0, v26
v_add_f32 v27, 1.0, v27
v_rcp_f32 v24, v24
v_rcp_f32 v25, v25
v_rcp_f32 v26, v26
v_rcp_f32 v27, v27
v_mul_f32 v64, v64, v24
v_mul_f32 v65, v65, v25
v_mul_f32 v66, v66, v26
v_mul_f32 v67, v67, v27
v_cvt_pk_bf16_f32 v36, v64, v65
v_cvt_pk_bf16_f32 v37, v66, v67
v_mov_b32 v64, v36
v_mov_b32 v65, v37
v_add_f32 v96, v96, v32
v_add_f32 v97, v97, v33
v_add_f32 v98, v98, v34
v_add_f32 v99, v99, v35
v_mul_f32 v28, v96, v96
v_mul_f32 v29, v97, v97
v_mul_f32 v30, v98, v98
v_mul_f32 v31, v99, v99
v_fmamk_f32 v28, v28, 0xbdd2d3e8, v6
v_fmamk_f32 v29, v29, 0xbdd2d3e8, v6
v_fmamk_f32 v30, v30, 0xbdd2d3e8, v6
v_fmamk_f32 v31, v31, 0xbdd2d3e8, v6
v_mul_f32 v28, v28, v96
v_mul_f32 v29, v29, v97
v_mul_f32 v30, v30, v98
v_mul_f32 v31, v31, v99
v_exp_f32 v28, v28
v_exp_f32 v29, v29
v_exp_f32 v30, v30
v_exp_f32 v31, v31
v_add_f32 v28, 1.0, v28
v_add_f32 v29, 1.0, v29
v_add_f32 v30, 1.0, v30
v_add_f32 v31, 1.0, v31
v_rcp_f32 v28, v28
v_rcp_f32 v29, v29
v_rcp_f32 v30, v30
v_rcp_f32 v31, v31
v_mul_f32 v96, v96, v28
v_mul_f32 v97, v97, v29
v_mul_f32 v98, v98, v30
v_mul_f32 v99, v99, v31
v_cvt_pk_bf16_f32 v38, v96, v97
v_cvt_pk_bf16_f32 v39, v98, v99
v_mov_b32 v96, v38
v_mov_b32 v97, v39
v_lshlrev_b32 v32, 16, v154
v_and_b32 v33, 0xffff0000, v154
v_lshlrev_b32 v34, 16, v155
v_and_b32 v35, 0xffff0000, v155
v_add_f32 v68, v68, v32
v_add_f32 v69, v69, v33
v_add_f32 v70, v70, v34
v_add_f32 v71, v71, v35
v_mul_f32 v24, v68, v68
v_mul_f32 v25, v69, v69
v_mul_f32 v26, v70, v70
v_mul_f32 v27, v71, v71
v_fmamk_f32 v24, v24, 0xbdd2d3e8, v6
v_fmamk_f32 v25, v25, 0xbdd2d3e8, v6
v_fmamk_f32 v26, v26, 0xbdd2d3e8, v6
v_fmamk_f32 v27, v27, 0xbdd2d3e8, v6
v_mul_f32 v24, v24, v68
v_mul_f32 v25, v25, v69
v_mul_f32 v26, v26, v70
v_mul_f32 v27, v27, v71
v_exp_f32 v24, v24
v_exp_f32 v25, v25
v_exp_f32 v26, v26
v_exp_f32 v27, v27
v_add_f32 v24, 1.0, v24
v_add_f32 v25, 1.0, v25
v_add_f32 v26, 1.0, v26
v_add_f32 v27, 1.0, v27
v_rcp_f32 v24, v24
v_rcp_f32 v25, v25
v_rcp_f32 v26, v26
v_rcp_f32 v27, v27
v_mul_f32 v68, v68, v24
v_mul_f32 v69, v69, v25
v_mul_f32 v70, v70, v26
v_mul_f32 v71, v71, v27
v_cvt_pk_bf16_f32 v36, v68, v69
v_cvt_pk_bf16_f32 v37, v70, v71
v_mov_b32 v66, v36
v_mov_b32 v67, v37
s_nop 1
v_permlane32_swap_b32 v64, v66
v_permlane32_swap_b32 v65, v67
s_nop 0
buffer_store_dwordx4 v[64:67], v40, s[16:19], s47 offen offset:64
v_add_f32 v100, v100, v32
v_add_f32 v101, v101, v33
v_add_f32 v102, v102, v34
v_add_f32 v103, v103, v35
v_mul_f32 v28, v100, v100
v_mul_f32 v29, v101, v101
v_mul_f32 v30, v102, v102
v_mul_f32 v31, v103, v103
v_fmamk_f32 v28, v28, 0xbdd2d3e8, v6
v_fmamk_f32 v29, v29, 0xbdd2d3e8, v6
v_fmamk_f32 v30, v30, 0xbdd2d3e8, v6
v_fmamk_f32 v31, v31, 0xbdd2d3e8, v6
v_mul_f32 v28, v28, v100
v_mul_f32 v29, v29, v101
v_mul_f32 v30, v30, v102
v_mul_f32 v31, v31, v103
v_exp_f32 v28, v28
v_exp_f32 v29, v29
v_exp_f32 v30, v30
v_exp_f32 v31, v31
v_add_f32 v28, 1.0, v28
v_add_f32 v29, 1.0, v29
v_add_f32 v30, 1.0, v30
v_add_f32 v31, 1.0, v31
v_rcp_f32 v28, v28
v_rcp_f32 v29, v29
v_rcp_f32 v30, v30
v_rcp_f32 v31, v31
v_mul_f32 v100, v100, v28
v_mul_f32 v101, v101, v29
v_mul_f32 v102, v102, v30
v_mul_f32 v103, v103, v31
v_cvt_pk_bf16_f32 v38, v100, v101
v_cvt_pk_bf16_f32 v39, v102, v103
v_mov_b32 v98, v38
v_mov_b32 v99, v39
s_nop 1
v_permlane32_swap_b32 v96, v98
v_permlane32_swap_b32 v97, v99
s_nop 0
buffer_store_dwordx4 v[96:99], v41, s[16:19], s47 offen offset:64
v_lshlrev_b32 v32, 16, v156
v_and_b32 v33, 0xffff0000, v156
v_lshlrev_b32 v34, 16, v157
v_and_b32 v35, 0xffff0000, v157
v_add_f32 v72, v72, v32
v_add_f32 v73, v73, v33
v_add_f32 v74, v74, v34
v_add_f32 v75, v75, v35
v_mul_f32 v24, v72, v72
v_mul_f32 v25, v73, v73
v_mul_f32 v26, v74, v74
v_mul_f32 v27, v75, v75
v_fmamk_f32 v24, v24, 0xbdd2d3e8, v6
v_fmamk_f32 v25, v25, 0xbdd2d3e8, v6
v_fmamk_f32 v26, v26, 0xbdd2d3e8, v6
v_fmamk_f32 v27, v27, 0xbdd2d3e8, v6
v_mul_f32 v24, v24, v72
v_mul_f32 v25, v25, v73
v_mul_f32 v26, v26, v74
v_mul_f32 v27, v27, v75
v_exp_f32 v24, v24
v_exp_f32 v25, v25
v_exp_f32 v26, v26
v_exp_f32 v27, v27
v_add_f32 v24, 1.0, v24
v_add_f32 v25, 1.0, v25
v_add_f32 v26, 1.0, v26
v_add_f32 v27, 1.0, v27
v_rcp_f32 v24, v24
v_rcp_f32 v25, v25
v_rcp_f32 v26, v26
v_rcp_f32 v27, v27
v_mul_f32 v72, v72, v24
v_mul_f32 v73, v73, v25
v_mul_f32 v74, v74, v26
v_mul_f32 v75, v75, v27
v_cvt_pk_bf16_f32 v36, v72, v73
v_cvt_pk_bf16_f32 v37, v74, v75
v_mov_b32 v72, v36
v_mov_b32 v73, v37
v_add_f32 v104, v104, v32
v_add_f32 v105, v105, v33
v_add_f32 v106, v106, v34
v_add_f32 v107, v107, v35
v_mul_f32 v28, v104, v104
v_mul_f32 v29, v105, v105
v_mul_f32 v30, v106, v106
v_mul_f32 v31, v107, v107
v_fmamk_f32 v28, v28, 0xbdd2d3e8, v6
v_fmamk_f32 v29, v29, 0xbdd2d3e8, v6
v_fmamk_f32 v30, v30, 0xbdd2d3e8, v6
v_fmamk_f32 v31, v31, 0xbdd2d3e8, v6
v_mul_f32 v28, v28, v104
v_mul_f32 v29, v29, v105
v_mul_f32 v30, v30, v106
v_mul_f32 v31, v31, v107
v_exp_f32 v28, v28
v_exp_f32 v29, v29
v_exp_f32 v30, v30
v_exp_f32 v31, v31
v_add_f32 v28, 1.0, v28
v_add_f32 v29, 1.0, v29
v_add_f32 v30, 1.0, v30
v_add_f32 v31, 1.0, v31
v_rcp_f32 v28, v28
v_rcp_f32 v29, v29
v_rcp_f32 v30, v30
v_rcp_f32 v31, v31
v_mul_f32 v104, v104, v28
v_mul_f32 v105, v105, v29
v_mul_f32 v106, v106, v30
v_mul_f32 v107, v107, v31
v_cvt_pk_bf16_f32 v38, v104, v105
v_cvt_pk_bf16_f32 v39, v106, v107
v_mov_b32 v104, v38
v_mov_b32 v105, v39
v_lshlrev_b32 v32, 16, v158
v_and_b32 v33, 0xffff0000, v158
v_lshlrev_b32 v34, 16, v159
v_and_b32 v35, 0xffff0000, v159
v_add_f32 v76, v76, v32
v_add_f32 v77, v77, v33
v_add_f32 v78, v78, v34
v_add_f32 v79, v79, v35
v_mul_f32 v24, v76, v76
v_mul_f32 v25, v77, v77
v_mul_f32 v26, v78, v78
v_mul_f32 v27, v79, v79
v_fmamk_f32 v24, v24, 0xbdd2d3e8, v6
v_fmamk_f32 v25, v25, 0xbdd2d3e8, v6
v_fmamk_f32 v26, v26, 0xbdd2d3e8, v6
v_fmamk_f32 v27, v27, 0xbdd2d3e8, v6
v_mul_f32 v24, v24, v76
v_mul_f32 v25, v25, v77
v_mul_f32 v26, v26, v78
v_mul_f32 v27, v27, v79
v_exp_f32 v24, v24
v_exp_f32 v25, v25
v_exp_f32 v26, v26
v_exp_f32 v27, v27
v_add_f32 v24, 1.0, v24
v_add_f32 v25, 1.0, v25
v_add_f32 v26, 1.0, v26
v_add_f32 v27, 1.0, v27
v_rcp_f32 v24, v24
v_rcp_f32 v25, v25
v_rcp_f32 v26, v26
v_rcp_f32 v27, v27
v_mul_f32 v76, v76, v24
v_mul_f32 v77, v77, v25
v_mul_f32 v78, v78, v26
v_mul_f32 v79, v79, v27
v_cvt_pk_bf16_f32 v36, v76, v77
v_cvt_pk_bf16_f32 v37, v78, v79
v_mov_b32 v74, v36
v_mov_b32 v75, v37
s_nop 1
v_permlane32_swap_b32 v72, v74
v_permlane32_swap_b32 v73, v75
s_nop 0
buffer_store_dwordx4 v[72:75], v40, s[16:19], s47 offen offset:96
v_add_f32 v108, v108, v32
v_add_f32 v109, v109, v33
v_add_f32 v110, v110, v34
v_add_f32 v111, v111, v35
v_mul_f32 v28, v108, v108
v_mul_f32 v29, v109, v109
v_mul_f32 v30, v110, v110
v_mul_f32 v31, v111, v111
v_fmamk_f32 v28, v28, 0xbdd2d3e8, v6
v_fmamk_f32 v29, v29, 0xbdd2d3e8, v6
v_fmamk_f32 v30, v30, 0xbdd2d3e8, v6
v_fmamk_f32 v31, v31, 0xbdd2d3e8, v6
v_mul_f32 v28, v28, v108
v_mul_f32 v29, v29, v109
v_mul_f32 v30, v30, v110
v_mul_f32 v31, v31, v111
v_exp_f32 v28, v28
v_exp_f32 v29, v29
v_exp_f32 v30, v30
v_exp_f32 v31, v31
v_add_f32 v28, 1.0, v28
v_add_f32 v29, 1.0, v29
v_add_f32 v30, 1.0, v30
v_add_f32 v31, 1.0, v31
v_rcp_f32 v28, v28
v_rcp_f32 v29, v29
v_rcp_f32 v30, v30
v_rcp_f32 v31, v31
v_mul_f32 v108, v108, v28
v_mul_f32 v109, v109, v29
v_mul_f32 v110, v110, v30
v_mul_f32 v111, v111, v31
v_cvt_pk_bf16_f32 v38, v108, v109
v_cvt_pk_bf16_f32 v39, v110, v111
v_mov_b32 v106, v38
v_mov_b32 v107, v39
s_nop 1
v_permlane32_swap_b32 v104, v106
v_permlane32_swap_b32 v105, v107
s_nop 0
buffer_store_dwordx4 v[104:107], v41, s[16:19], s47 offen offset:96
K1_DONE:

s_waitcnt vmcnt(0)

K1_END:
s_endpgm
.section .rodata,"a"
.p2align 6
.amdhsa_kernel mha_k1_kernel
  .amdhsa_next_free_vgpr 160
  .amdhsa_next_free_sgpr 96
  .amdhsa_accum_offset 160
  .amdhsa_group_segment_fixed_size 0
  .amdhsa_kernarg_size 88
  .amdhsa_user_sgpr_count 2
  .amdhsa_user_sgpr_kernarg_segment_ptr 1
  .amdhsa_system_sgpr_workgroup_id_x 1
.end_amdhsa_kernel
.text
.globl mha_k2_kernel
.p2align 8
.type mha_k2_kernel,@function
mha_k2_kernel:
s_cmp_ge_u32 s2, 512
s_cbranch_scc1 K2_END
s_cmp_lt_u32 s2, 256
s_cbranch_scc1 K2_ATT
s_and_b32 s40, s2, 31
s_lshr_b32 s41, s2, 5
s_and_b32 s41, s41, 7
s_setprio 3
s_load_dwordx2 s[42:43], s[0:1], 48
s_load_dwordx2 s[44:45], s[0:1], 80
v_lshrrev_b32 v2, 6, v0
v_and_b32 v1, 63, v0
v_readfirstlane_b32 s46, v2
s_cmp_ge_u32 s46, 4
s_cbranch_scc1 F2_END
s_and_b32 s47, s46, 1
s_lshr_b32 s48, s46, 1
s_waitcnt lgkmcnt(0)
s_mov_b32 s8, s42
s_mov_b32 s9, s43
s_mov_b32 s10, 1835008
s_mov_b32 s11, 0x00020000
s_add_u32 s12, s44, 6291456
s_addc_u32 s13, s45, 0
s_mov_b32 s14, 9437184
s_mov_b32 s15, 0x00020000
v_lshrrev_b32 v2, 3, v1
v_lshrrev_b32 v3, 4, v1
v_and_b32 v3, 1, v3
v_lshlrev_b32 v3, 2, v3
v_and_b32 v4, 7, v1
v_xor_b32 v3, v3, v4
s_lshl_b32 s49, s46, 4
v_add_u32 v2, s49, v2
v_lshlrev_b32 v6, 10, v2
v_lshl_add_u32 v6, v3, 4, v6
s_lshl_b32 s50, s41, 7
v_lshrrev_b32 v3, 3, v1
v_and_b32 v4, 7, v1
v_xor_b32 v4, v4, v3
s_lshl_b32 s51, s46, 1
s_and_b32 s51, s51, 3
v_xor_b32 v4, s51, v4
s_lshl_b32 s51, s40, 6
s_add_u32 s51, s51, s49
v_add_u32 v3, s51, v3
s_mov_b32 s52, 4608
v_mul_lo_u32 v7, v3, s52
v_lshl_add_u32 v7, v4, 4, v7
s_lshl_b32 s53, s46, 11
v_lshrrev_b32 v2, 5, v1
v_and_b32 v3, 15, v1
v_lshrrev_b32 v4, 2, v3
v_lshl_add_u32 v5, v2, 3, v4
v_lshlrev_b32 v5, 7, v5
v_and_b32 v3, 3, v3
v_lshl_add_u32 v5, v3, 3, v5
v_lshrrev_b32 v2, 4, v1
v_and_b32 v2, 1, v2
v_lshl_add_u32 v5, v2, 5, v5
v_lshrrev_b32 v4, 1, v4
v_xor_b32 v2, s48, v4
v_lshl_add_u32 v8, v2, 6, v5
v_and_b32 v2, 31, v1
s_lshl_b32 s54, s47, 5
v_add_u32 v3, s54, v2
v_lshlrev_b32 v3, 7, v3
v_add_u32 v3, 8192, v3
v_and_b32 v4, 7, v2
v_lshrrev_b32 v2, 3, v2
v_xor_b32 v4, v4, v2
v_lshrrev_b32 v2, 5, v1
v_xor_b32 v4, v4, v2
v_lshl_add_u32 v9, v4, 4, v3
v_xor_b32 v10, 32, v9
v_xor_b32 v11, 64, v9
v_xor_b32 v12, 96, v9
v_mov_b32 v16, 0
v_mov_b32 v17, 0
v_mov_b32 v18, 0
v_mov_b32 v19, 0
v_mov_b32 v20, 0
v_mov_b32 v21, 0
v_mov_b32 v22, 0
v_mov_b32 v23, 0
v_mov_b32 v24, 0
v_mov_b32 v25, 0
v_mov_b32 v26, 0
v_mov_b32 v27, 0
v_mov_b32 v28, 0
v_mov_b32 v29, 0
v_mov_b32 v30, 0
v_mov_b32 v31, 0
s_add_u32 m0, s53, 0
s_add_u32 s55, s50, 0
buffer_load_dwordx4 v6, s[8:11], s55 offen lds
s_add_u32 m0, s53, 1024
s_add_u32 s55, s50, 8192
buffer_load_dwordx4 v6, s[8:11], s55 offen lds
s_add_u32 m0, s53, 8192
s_mov_b32 s55, 1024
buffer_load_dwordx4 v7, s[12:15], s55 offen lds
s_add_u32 m0, s53, 9216
s_mov_b32 s55, 37888
v_xor_b32 v5, 16, v7
buffer_load_dwordx4 v5, s[12:15], s55 offen lds
s_add_u32 m0, s53, 16384
s_add_u32 s55, s50, 65536
buffer_load_dwordx4 v6, s[8:11], s55 offen lds
s_add_u32 m0, s53, 17408
s_add_u32 s55, s50, 73728
buffer_load_dwordx4 v6, s[8:11], s55 offen lds
s_add_u32 m0, s53, 24576
s_mov_b32 s55, 1152
buffer_load_dwordx4 v7, s[12:15], s55 offen lds
s_add_u32 m0, s53, 25600
s_mov_b32 s55, 38016
v_xor_b32 v5, 16, v7
buffer_load_dwordx4 v5, s[12:15], s55 offen lds
s_waitcnt vmcnt(4)
s_barrier
ds_read_b64_tr_b16 v[32:33], v8 offset:0
ds_read_b64_tr_b16 v[34:35], v8 offset:512
ds_read_b128 v[40:43], v9
s_waitcnt lgkmcnt(0)
ds_read_b64_tr_b16 v[36:37], v8 offset:2048
ds_read_b64_tr_b16 v[38:39], v8 offset:2560
ds_read_b128 v[44:47], v10
v_mfma_f32_32x32x16_bf16 v[16:31], v[32:35], v[40:43], v[16:31]
s_add_u32 m0, s53, 32768
s_add_u32 s55, s50, 131072
buffer_load_dwordx4 v6, s[8:11], s55 offen lds
s_add_u32 m0, s53, 33792
s_add_u32 s55, s50, 139264
buffer_load_dwordx4 v6, s[8:11], s55 offen lds
s_waitcnt lgkmcnt(0)
ds_read_b64_tr_b16 v[32:33], v8 offset:4096
ds_read_b64_tr_b16 v[34:35], v8 offset:4608
ds_read_b128 v[40:43], v11
v_mfma_f32_32x32x16_bf16 v[16:31], v[36:39], v[44:47], v[16:31]
s_add_u32 m0, s53, 40960
s_mov_b32 s55, 1280
buffer_load_dwordx4 v7, s[12:15], s55 offen lds
s_add_u32 m0, s53, 41984
s_mov_b32 s55, 38144
v_xor_b32 v5, 16, v7
buffer_load_dwordx4 v5, s[12:15], s55 offen lds
s_waitcnt lgkmcnt(0)
ds_read_b64_tr_b16 v[36:37], v8 offset:6144
ds_read_b64_tr_b16 v[38:39], v8 offset:6656
ds_read_b128 v[44:47], v12
v_mfma_f32_32x32x16_bf16 v[16:31], v[32:35], v[40:43], v[16:31]
s_waitcnt lgkmcnt(0)
s_waitcnt vmcnt(4)
s_barrier
v_add_u32 v8, 16384, v8
v_add_u32 v9, 16384, v9
v_add_u32 v10, 16384, v10
v_add_u32 v11, 16384, v11
v_add_u32 v12, 16384, v12
ds_read_b64_tr_b16 v[32:33], v8 offset:0
ds_read_b64_tr_b16 v[34:35], v8 offset:512
ds_read_b128 v[40:43], v9
v_mfma_f32_32x32x16_bf16 v[16:31], v[36:39], v[44:47], v[16:31]
s_add_u32 m0, s53, 0
s_add_u32 s55, s50, 196608
buffer_load_dwordx4 v6, s[8:11], s55 offen lds
s_add_u32 m0, s53, 1024
s_add_u32 s55, s50, 204800
buffer_load_dwordx4 v6, s[8:11], s55 offen lds
s_waitcnt lgkmcnt(0)
ds_read_b64_tr_b16 v[36:37], v8 offset:2048
ds_read_b64_tr_b16 v[38:39], v8 offset:2560
ds_read_b128 v[44:47], v10
v_mfma_f32_32x32x16_bf16 v[16:31], v[32:35], v[40:43], v[16:31]
s_add_u32 m0, s53, 8192
s_mov_b32 s55, 1408
buffer_load_dwordx4 v7, s[12:15], s55 offen lds
s_add_u32 m0, s53, 9216
s_mov_b32 s55, 38272
v_xor_b32 v5, 16, v7
buffer_load_dwordx4 v5, s[12:15], s55 offen lds
s_waitcnt lgkmcnt(0)
ds_read_b64_tr_b16 v[32:33], v8 offset:4096
ds_read_b64_tr_b16 v[34:35], v8 offset:4608
ds_read_b128 v[40:43], v11
v_mfma_f32_32x32x16_bf16 v[16:31], v[36:39], v[44:47], v[16:31]
s_waitcnt lgkmcnt(0)
ds_read_b64_tr_b16 v[36:37], v8 offset:6144
ds_read_b64_tr_b16 v[38:39], v8 offset:6656
ds_read_b128 v[44:47], v12
v_mfma_f32_32x32x16_bf16 v[16:31], v[32:35], v[40:43], v[16:31]
s_waitcnt lgkmcnt(0)
s_waitcnt vmcnt(4)
s_barrier
v_add_u32 v8, 16384, v8
v_add_u32 v9, 16384, v9
v_add_u32 v10, 16384, v10
v_add_u32 v11, 16384, v11
v_add_u32 v12, 16384, v12
ds_read_b64_tr_b16 v[32:33], v8 offset:0
ds_read_b64_tr_b16 v[34:35], v8 offset:512
ds_read_b128 v[40:43], v9
v_mfma_f32_32x32x16_bf16 v[16:31], v[36:39], v[44:47], v[16:31]
s_add_u32 m0, s53, 16384
s_add_u32 s55, s50, 262144
buffer_load_dwordx4 v6, s[8:11], s55 offen lds
s_add_u32 m0, s53, 17408
s_add_u32 s55, s50, 270336
buffer_load_dwordx4 v6, s[8:11], s55 offen lds
s_waitcnt lgkmcnt(0)
ds_read_b64_tr_b16 v[36:37], v8 offset:2048
ds_read_b64_tr_b16 v[38:39], v8 offset:2560
ds_read_b128 v[44:47], v10
v_mfma_f32_32x32x16_bf16 v[16:31], v[32:35], v[40:43], v[16:31]
s_add_u32 m0, s53, 24576
s_mov_b32 s55, 1536
buffer_load_dwordx4 v7, s[12:15], s55 offen lds
s_add_u32 m0, s53, 25600
s_mov_b32 s55, 38400
v_xor_b32 v5, 16, v7
buffer_load_dwordx4 v5, s[12:15], s55 offen lds
s_waitcnt lgkmcnt(0)
ds_read_b64_tr_b16 v[32:33], v8 offset:4096
ds_read_b64_tr_b16 v[34:35], v8 offset:4608
ds_read_b128 v[40:43], v11
v_mfma_f32_32x32x16_bf16 v[16:31], v[36:39], v[44:47], v[16:31]
s_waitcnt lgkmcnt(0)
ds_read_b64_tr_b16 v[36:37], v8 offset:6144
ds_read_b64_tr_b16 v[38:39], v8 offset:6656
ds_read_b128 v[44:47], v12
v_mfma_f32_32x32x16_bf16 v[16:31], v[32:35], v[40:43], v[16:31]
s_waitcnt lgkmcnt(0)
s_waitcnt vmcnt(4)
s_barrier
v_add_u32 v8, 0xffff8000, v8
v_add_u32 v9, 0xffff8000, v9
v_add_u32 v10, 0xffff8000, v10
v_add_u32 v11, 0xffff8000, v11
v_add_u32 v12, 0xffff8000, v12
ds_read_b64_tr_b16 v[32:33], v8 offset:0
ds_read_b64_tr_b16 v[34:35], v8 offset:512
ds_read_b128 v[40:43], v9
v_mfma_f32_32x32x16_bf16 v[16:31], v[36:39], v[44:47], v[16:31]
s_add_u32 m0, s53, 32768
s_add_u32 s55, s50, 327680
buffer_load_dwordx4 v6, s[8:11], s55 offen lds
s_add_u32 m0, s53, 33792
s_add_u32 s55, s50, 335872
buffer_load_dwordx4 v6, s[8:11], s55 offen lds
s_waitcnt lgkmcnt(0)
ds_read_b64_tr_b16 v[36:37], v8 offset:2048
ds_read_b64_tr_b16 v[38:39], v8 offset:2560
ds_read_b128 v[44:47], v10
v_mfma_f32_32x32x16_bf16 v[16:31], v[32:35], v[40:43], v[16:31]
s_add_u32 m0, s53, 40960
s_mov_b32 s55, 1664
buffer_load_dwordx4 v7, s[12:15], s55 offen lds
s_add_u32 m0, s53, 41984
s_mov_b32 s55, 38528
v_xor_b32 v5, 16, v7
buffer_load_dwordx4 v5, s[12:15], s55 offen lds
s_waitcnt lgkmcnt(0)
ds_read_b64_tr_b16 v[32:33], v8 offset:4096
ds_read_b64_tr_b16 v[34:35], v8 offset:4608
ds_read_b128 v[40:43], v11
v_mfma_f32_32x32x16_bf16 v[16:31], v[36:39], v[44:47], v[16:31]
s_waitcnt lgkmcnt(0)
ds_read_b64_tr_b16 v[36:37], v8 offset:6144
ds_read_b64_tr_b16 v[38:39], v8 offset:6656
ds_read_b128 v[44:47], v12
v_mfma_f32_32x32x16_bf16 v[16:31], v[32:35], v[40:43], v[16:31]
s_waitcnt lgkmcnt(0)
s_waitcnt vmcnt(4)
s_barrier
v_add_u32 v8, 16384, v8
v_add_u32 v9, 16384, v9
v_add_u32 v10, 16384, v10
v_add_u32 v11, 16384, v11
v_add_u32 v12, 16384, v12
ds_read_b64_tr_b16 v[32:33], v8 offset:0
ds_read_b64_tr_b16 v[34:35], v8 offset:512
ds_read_b128 v[40:43], v9
v_mfma_f32_32x32x16_bf16 v[16:31], v[36:39], v[44:47], v[16:31]
s_add_u32 m0, s53, 0
s_add_u32 s55, s50, 393216
buffer_load_dwordx4 v6, s[8:11], s55 offen lds
s_add_u32 m0, s53, 1024
s_add_u32 s55, s50, 401408
buffer_load_dwordx4 v6, s[8:11], s55 offen lds
s_waitcnt lgkmcnt(0)
ds_read_b64_tr_b16 v[36:37], v8 offset:2048
ds_read_b64_tr_b16 v[38:39], v8 offset:2560
ds_read_b128 v[44:47], v10
v_mfma_f32_32x32x16_bf16 v[16:31], v[32:35], v[40:43], v[16:31]
s_add_u32 m0, s53, 8192
s_mov_b32 s55, 1792
buffer_load_dwordx4 v7, s[12:15], s55 offen lds
s_add_u32 m0, s53, 9216
s_mov_b32 s55, 38656
v_xor_b32 v5, 16, v7
buffer_load_dwordx4 v5, s[12:15], s55 offen lds
s_waitcnt lgkmcnt(0)
ds_read_b64_tr_b16 v[32:33], v8 offset:4096
ds_read_b64_tr_b16 v[34:35], v8 offset:4608
ds_read_b128 v[40:43], v11
v_mfma_f32_32x32x16_bf16 v[16:31], v[36:39], v[44:47], v[16:31]
s_waitcnt lgkmcnt(0)
ds_read_b64_tr_b16 v[36:37], v8 offset:6144
ds_read_b64_tr_b16 v[38:39], v8 offset:6656
ds_read_b128 v[44:47], v12
v_mfma_f32_32x32x16_bf16 v[16:31], v[32:35], v[40:43], v[16:31]
s_waitcnt lgkmcnt(0)
s_waitcnt vmcnt(4)
s_barrier
v_add_u32 v8, 16384, v8
v_add_u32 v9, 16384, v9
v_add_u32 v10, 16384, v10
v_add_u32 v11, 16384, v11
v_add_u32 v12, 16384, v12
ds_read_b64_tr_b16 v[32:33], v8 offset:0
ds_read_b64_tr_b16 v[34:35], v8 offset:512
ds_read_b128 v[40:43], v9
v_mfma_f32_32x32x16_bf16 v[16:31], v[36:39], v[44:47], v[16:31]
s_add_u32 m0, s53, 16384
s_add_u32 s55, s50, 458752
buffer_load_dwordx4 v6, s[8:11], s55 offen lds
s_add_u32 m0, s53, 17408
s_add_u32 s55, s50, 466944
buffer_load_dwordx4 v6, s[8:11], s55 offen lds
s_waitcnt lgkmcnt(0)
ds_read_b64_tr_b16 v[36:37], v8 offset:2048
ds_read_b64_tr_b16 v[38:39], v8 offset:2560
ds_read_b128 v[44:47], v10
v_mfma_f32_32x32x16_bf16 v[16:31], v[32:35], v[40:43], v[16:31]
s_add_u32 m0, s53, 24576
s_mov_b32 s55, 1920
buffer_load_dwordx4 v7, s[12:15], s55 offen lds
s_add_u32 m0, s53, 25600
s_mov_b32 s55, 38784
v_xor_b32 v5, 16, v7
buffer_load_dwordx4 v5, s[12:15], s55 offen lds
s_waitcnt lgkmcnt(0)
ds_read_b64_tr_b16 v[32:33], v8 offset:4096
ds_read_b64_tr_b16 v[34:35], v8 offset:4608
ds_read_b128 v[40:43], v11
v_mfma_f32_32x32x16_bf16 v[16:31], v[36:39], v[44:47], v[16:31]
s_waitcnt lgkmcnt(0)
ds_read_b64_tr_b16 v[36:37], v8 offset:6144
ds_read_b64_tr_b16 v[38:39], v8 offset:6656
ds_read_b128 v[44:47], v12
v_mfma_f32_32x32x16_bf16 v[16:31], v[32:35], v[40:43], v[16:31]
s_waitcnt lgkmcnt(0)
s_waitcnt vmcnt(4)
s_barrier
v_add_u32 v8, 0xffff8000, v8
v_add_u32 v9, 0xffff8000, v9
v_add_u32 v10, 0xffff8000, v10
v_add_u32 v11, 0xffff8000, v11
v_add_u32 v12, 0xffff8000, v12
ds_read_b64_tr_b16 v[32:33], v8 offset:0
ds_read_b64_tr_b16 v[34:35], v8 offset:512
ds_read_b128 v[40:43], v9
v_mfma_f32_32x32x16_bf16 v[16:31], v[36:39], v[44:47], v[16:31]
s_add_u32 m0, s53, 32768
s_add_u32 s55, s50, 524288
buffer_load_dwordx4 v6, s[8:11], s55 offen lds
s_add_u32 m0, s53, 33792
s_add_u32 s55, s50, 532480
buffer_load_dwordx4 v6, s[8:11], s55 offen lds
s_waitcnt lgkmcnt(0)
ds_read_b64_tr_b16 v[36:37], v8 offset:2048
ds_read_b64_tr_b16 v[38:39], v8 offset:2560
ds_read_b128 v[44:47], v10
v_mfma_f32_32x32x16_bf16 v[16:31], v[32:35], v[40:43], v[16:31]
s_add_u32 m0, s53, 40960
s_mov_b32 s55, 2048
buffer_load_dwordx4 v7, s[12:15], s55 offen lds
s_add_u32 m0, s53, 41984
s_mov_b32 s55, 38912
v_xor_b32 v5, 16, v7
buffer_load_dwordx4 v5, s[12:15], s55 offen lds
s_waitcnt lgkmcnt(0)
ds_read_b64_tr_b16 v[32:33], v8 offset:4096
ds_read_b64_tr_b16 v[34:35], v8 offset:4608
ds_read_b128 v[40:43], v11
v_mfma_f32_32x32x16_bf16 v[16:31], v[36:39], v[44:47], v[16:31]
s_waitcnt lgkmcnt(0)
ds_read_b64_tr_b16 v[36:37], v8 offset:6144
ds_read_b64_tr_b16 v[38:39], v8 offset:6656
ds_read_b128 v[44:47], v12
v_mfma_f32_32x32x16_bf16 v[16:31], v[32:35], v[40:43], v[16:31]
s_waitcnt lgkmcnt(0)
s_waitcnt vmcnt(4)
s_barrier
v_add_u32 v8, 16384, v8
v_add_u32 v9, 16384, v9
v_add_u32 v10, 16384, v10
v_add_u32 v11, 16384, v11
v_add_u32 v12, 16384, v12
ds_read_b64_tr_b16 v[32:33], v8 offset:0
ds_read_b64_tr_b16 v[34:35], v8 offset:512
ds_read_b128 v[40:43], v9
v_mfma_f32_32x32x16_bf16 v[16:31], v[36:39], v[44:47], v[16:31]
s_add_u32 m0, s53, 0
s_add_u32 s55, s50, 589824
buffer_load_dwordx4 v6, s[8:11], s55 offen lds
s_add_u32 m0, s53, 1024
s_add_u32 s55, s50, 598016
buffer_load_dwordx4 v6, s[8:11], s55 offen lds
s_waitcnt lgkmcnt(0)
ds_read_b64_tr_b16 v[36:37], v8 offset:2048
ds_read_b64_tr_b16 v[38:39], v8 offset:2560
ds_read_b128 v[44:47], v10
v_mfma_f32_32x32x16_bf16 v[16:31], v[32:35], v[40:43], v[16:31]
s_add_u32 m0, s53, 8192
s_mov_b32 s55, 2176
buffer_load_dwordx4 v7, s[12:15], s55 offen lds
s_add_u32 m0, s53, 9216
s_mov_b32 s55, 39040
v_xor_b32 v5, 16, v7
buffer_load_dwordx4 v5, s[12:15], s55 offen lds
s_waitcnt lgkmcnt(0)
ds_read_b64_tr_b16 v[32:33], v8 offset:4096
ds_read_b64_tr_b16 v[34:35], v8 offset:4608
ds_read_b128 v[40:43], v11
v_mfma_f32_32x32x16_bf16 v[16:31], v[36:39], v[44:47], v[16:31]
s_waitcnt lgkmcnt(0)
ds_read_b64_tr_b16 v[36:37], v8 offset:6144
ds_read_b64_tr_b16 v[38:39], v8 offset:6656
ds_read_b128 v[44:47], v12
v_mfma_f32_32x32x16_bf16 v[16:31], v[32:35], v[40:43], v[16:31]
s_waitcnt lgkmcnt(0)
s_waitcnt vmcnt(4)
s_barrier
v_add_u32 v8, 16384, v8
v_add_u32 v9, 16384, v9
v_add_u32 v10, 16384, v10
v_add_u32 v11, 16384, v11
v_add_u32 v12, 16384, v12
ds_read_b64_tr_b16 v[32:33], v8 offset:0
ds_read_b64_tr_b16 v[34:35], v8 offset:512
ds_read_b128 v[40:43], v9
v_mfma_f32_32x32x16_bf16 v[16:31], v[36:39], v[44:47], v[16:31]
s_add_u32 m0, s53, 16384
s_add_u32 s55, s50, 655360
buffer_load_dwordx4 v6, s[8:11], s55 offen lds
s_add_u32 m0, s53, 17408
s_add_u32 s55, s50, 663552
buffer_load_dwordx4 v6, s[8:11], s55 offen lds
s_waitcnt lgkmcnt(0)
ds_read_b64_tr_b16 v[36:37], v8 offset:2048
ds_read_b64_tr_b16 v[38:39], v8 offset:2560
ds_read_b128 v[44:47], v10
v_mfma_f32_32x32x16_bf16 v[16:31], v[32:35], v[40:43], v[16:31]
s_add_u32 m0, s53, 24576
s_mov_b32 s55, 2304
buffer_load_dwordx4 v7, s[12:15], s55 offen lds
s_add_u32 m0, s53, 25600
s_mov_b32 s55, 39168
v_xor_b32 v5, 16, v7
buffer_load_dwordx4 v5, s[12:15], s55 offen lds
s_waitcnt lgkmcnt(0)
ds_read_b64_tr_b16 v[32:33], v8 offset:4096
ds_read_b64_tr_b16 v[34:35], v8 offset:4608
ds_read_b128 v[40:43], v11
v_mfma_f32_32x32x16_bf16 v[16:31], v[36:39], v[44:47], v[16:31]
s_waitcnt lgkmcnt(0)
ds_read_b64_tr_b16 v[36:37], v8 offset:6144
ds_read_b64_tr_b16 v[38:39], v8 offset:6656
ds_read_b128 v[44:47], v12
v_mfma_f32_32x32x16_bf16 v[16:31], v[32:35], v[40:43], v[16:31]
s_waitcnt lgkmcnt(0)
s_waitcnt vmcnt(4)
s_barrier
v_add_u32 v8, 0xffff8000, v8
v_add_u32 v9, 0xffff8000, v9
v_add_u32 v10, 0xffff8000, v10
v_add_u32 v11, 0xffff8000, v11
v_add_u32 v12, 0xffff8000, v12
ds_read_b64_tr_b16 v[32:33], v8 offset:0
ds_read_b64_tr_b16 v[34:35], v8 offset:512
ds_read_b128 v[40:43], v9
v_mfma_f32_32x32x16_bf16 v[16:31], v[36:39], v[44:47], v[16:31]
s_add_u32 m0, s53, 32768
s_add_u32 s55, s50, 720896
buffer_load_dwordx4 v6, s[8:11], s55 offen lds
s_add_u32 m0, s53, 33792
s_add_u32 s55, s50, 729088
buffer_load_dwordx4 v6, s[8:11], s55 offen lds
s_waitcnt lgkmcnt(0)
ds_read_b64_tr_b16 v[36:37], v8 offset:2048
ds_read_b64_tr_b16 v[38:39], v8 offset:2560
ds_read_b128 v[44:47], v10
v_mfma_f32_32x32x16_bf16 v[16:31], v[32:35], v[40:43], v[16:31]
s_add_u32 m0, s53, 40960
s_mov_b32 s55, 2432
buffer_load_dwordx4 v7, s[12:15], s55 offen lds
s_add_u32 m0, s53, 41984
s_mov_b32 s55, 39296
v_xor_b32 v5, 16, v7
buffer_load_dwordx4 v5, s[12:15], s55 offen lds
s_waitcnt lgkmcnt(0)
ds_read_b64_tr_b16 v[32:33], v8 offset:4096
ds_read_b64_tr_b16 v[34:35], v8 offset:4608
ds_read_b128 v[40:43], v11
v_mfma_f32_32x32x16_bf16 v[16:31], v[36:39], v[44:47], v[16:31]
s_waitcnt lgkmcnt(0)
ds_read_b64_tr_b16 v[36:37], v8 offset:6144
ds_read_b64_tr_b16 v[38:39], v8 offset:6656
ds_read_b128 v[44:47], v12
v_mfma_f32_32x32x16_bf16 v[16:31], v[32:35], v[40:43], v[16:31]
s_waitcnt lgkmcnt(0)
s_waitcnt vmcnt(4)
s_barrier
v_add_u32 v8, 16384, v8
v_add_u32 v9, 16384, v9
v_add_u32 v10, 16384, v10
v_add_u32 v11, 16384, v11
v_add_u32 v12, 16384, v12
ds_read_b64_tr_b16 v[32:33], v8 offset:0
ds_read_b64_tr_b16 v[34:35], v8 offset:512
ds_read_b128 v[40:43], v9
v_mfma_f32_32x32x16_bf16 v[16:31], v[36:39], v[44:47], v[16:31]
s_add_u32 m0, s53, 0
s_add_u32 s55, s50, 786432
buffer_load_dwordx4 v6, s[8:11], s55 offen lds
s_add_u32 m0, s53, 1024
s_add_u32 s55, s50, 794624
buffer_load_dwordx4 v6, s[8:11], s55 offen lds
s_waitcnt lgkmcnt(0)
ds_read_b64_tr_b16 v[36:37], v8 offset:2048
ds_read_b64_tr_b16 v[38:39], v8 offset:2560
ds_read_b128 v[44:47], v10
v_mfma_f32_32x32x16_bf16 v[16:31], v[32:35], v[40:43], v[16:31]
s_add_u32 m0, s53, 8192
s_mov_b32 s55, 2560
buffer_load_dwordx4 v7, s[12:15], s55 offen lds
s_add_u32 m0, s53, 9216
s_mov_b32 s55, 39424
v_xor_b32 v5, 16, v7
buffer_load_dwordx4 v5, s[12:15], s55 offen lds
s_waitcnt lgkmcnt(0)
ds_read_b64_tr_b16 v[32:33], v8 offset:4096
ds_read_b64_tr_b16 v[34:35], v8 offset:4608
ds_read_b128 v[40:43], v11
v_mfma_f32_32x32x16_bf16 v[16:31], v[36:39], v[44:47], v[16:31]
s_waitcnt lgkmcnt(0)
ds_read_b64_tr_b16 v[36:37], v8 offset:6144
ds_read_b64_tr_b16 v[38:39], v8 offset:6656
ds_read_b128 v[44:47], v12
v_mfma_f32_32x32x16_bf16 v[16:31], v[32:35], v[40:43], v[16:31]
s_waitcnt lgkmcnt(0)
s_waitcnt vmcnt(4)
s_barrier
v_add_u32 v8, 16384, v8
v_add_u32 v9, 16384, v9
v_add_u32 v10, 16384, v10
v_add_u32 v11, 16384, v11
v_add_u32 v12, 16384, v12
ds_read_b64_tr_b16 v[32:33], v8 offset:0
ds_read_b64_tr_b16 v[34:35], v8 offset:512
ds_read_b128 v[40:43], v9
v_mfma_f32_32x32x16_bf16 v[16:31], v[36:39], v[44:47], v[16:31]
s_add_u32 m0, s53, 16384
s_add_u32 s55, s50, 851968
buffer_load_dwordx4 v6, s[8:11], s55 offen lds
s_add_u32 m0, s53, 17408
s_add_u32 s55, s50, 860160
buffer_load_dwordx4 v6, s[8:11], s55 offen lds
s_waitcnt lgkmcnt(0)
ds_read_b64_tr_b16 v[36:37], v8 offset:2048
ds_read_b64_tr_b16 v[38:39], v8 offset:2560
ds_read_b128 v[44:47], v10
v_mfma_f32_32x32x16_bf16 v[16:31], v[32:35], v[40:43], v[16:31]
s_add_u32 m0, s53, 24576
s_mov_b32 s55, 2688
buffer_load_dwordx4 v7, s[12:15], s55 offen lds
s_add_u32 m0, s53, 25600
s_mov_b32 s55, 39552
v_xor_b32 v5, 16, v7
buffer_load_dwordx4 v5, s[12:15], s55 offen lds
s_waitcnt lgkmcnt(0)
ds_read_b64_tr_b16 v[32:33], v8 offset:4096
ds_read_b64_tr_b16 v[34:35], v8 offset:4608
ds_read_b128 v[40:43], v11
v_mfma_f32_32x32x16_bf16 v[16:31], v[36:39], v[44:47], v[16:31]
s_waitcnt lgkmcnt(0)
ds_read_b64_tr_b16 v[36:37], v8 offset:6144
ds_read_b64_tr_b16 v[38:39], v8 offset:6656
ds_read_b128 v[44:47], v12
v_mfma_f32_32x32x16_bf16 v[16:31], v[32:35], v[40:43], v[16:31]
s_waitcnt lgkmcnt(0)
s_waitcnt vmcnt(4)
s_barrier
v_add_u32 v8, 0xffff8000, v8
v_add_u32 v9, 0xffff8000, v9
v_add_u32 v10, 0xffff8000, v10
v_add_u32 v11, 0xffff8000, v11
v_add_u32 v12, 0xffff8000, v12
ds_read_b64_tr_b16 v[32:33], v8 offset:0
ds_read_b64_tr_b16 v[34:35], v8 offset:512
ds_read_b128 v[40:43], v9
v_mfma_f32_32x32x16_bf16 v[16:31], v[36:39], v[44:47], v[16:31]
s_add_u32 m0, s53, 32768
s_add_u32 s55, s50, 917504
buffer_load_dwordx4 v6, s[8:11], s55 offen lds
s_add_u32 m0, s53, 33792
s_add_u32 s55, s50, 925696
buffer_load_dwordx4 v6, s[8:11], s55 offen lds
s_waitcnt lgkmcnt(0)
ds_read_b64_tr_b16 v[36:37], v8 offset:2048
ds_read_b64_tr_b16 v[38:39], v8 offset:2560
ds_read_b128 v[44:47], v10
v_mfma_f32_32x32x16_bf16 v[16:31], v[32:35], v[40:43], v[16:31]
s_add_u32 m0, s53, 40960
s_mov_b32 s55, 2816
buffer_load_dwordx4 v7, s[12:15], s55 offen lds
s_add_u32 m0, s53, 41984
s_mov_b32 s55, 39680
v_xor_b32 v5, 16, v7
buffer_load_dwordx4 v5, s[12:15], s55 offen lds
s_waitcnt lgkmcnt(0)
ds_read_b64_tr_b16 v[32:33], v8 offset:4096
ds_read_b64_tr_b16 v[34:35], v8 offset:4608
ds_read_b128 v[40:43], v11
v_mfma_f32_32x32x16_bf16 v[16:31], v[36:39], v[44:47], v[16:31]
s_waitcnt lgkmcnt(0)
ds_read_b64_tr_b16 v[36:37], v8 offset:6144
ds_read_b64_tr_b16 v[38:39], v8 offset:6656
ds_read_b128 v[44:47], v12
v_mfma_f32_32x32x16_bf16 v[16:31], v[32:35], v[40:43], v[16:31]
s_waitcnt lgkmcnt(0)
s_waitcnt vmcnt(4)
s_barrier
v_add_u32 v8, 16384, v8
v_add_u32 v9, 16384, v9
v_add_u32 v10, 16384, v10
v_add_u32 v11, 16384, v11
v_add_u32 v12, 16384, v12
ds_read_b64_tr_b16 v[32:33], v8 offset:0
ds_read_b64_tr_b16 v[34:35], v8 offset:512
ds_read_b128 v[40:43], v9
v_mfma_f32_32x32x16_bf16 v[16:31], v[36:39], v[44:47], v[16:31]
s_add_u32 m0, s53, 0
s_add_u32 s55, s50, 983040
buffer_load_dwordx4 v6, s[8:11], s55 offen lds
s_add_u32 m0, s53, 1024
s_add_u32 s55, s50, 991232
buffer_load_dwordx4 v6, s[8:11], s55 offen lds
s_waitcnt lgkmcnt(0)
ds_read_b64_tr_b16 v[36:37], v8 offset:2048
ds_read_b64_tr_b16 v[38:39], v8 offset:2560
ds_read_b128 v[44:47], v10
v_mfma_f32_32x32x16_bf16 v[16:31], v[32:35], v[40:43], v[16:31]
s_add_u32 m0, s53, 8192
s_mov_b32 s55, 2944
buffer_load_dwordx4 v7, s[12:15], s55 offen lds
s_add_u32 m0, s53, 9216
s_mov_b32 s55, 39808
v_xor_b32 v5, 16, v7
buffer_load_dwordx4 v5, s[12:15], s55 offen lds
s_waitcnt lgkmcnt(0)
ds_read_b64_tr_b16 v[32:33], v8 offset:4096
ds_read_b64_tr_b16 v[34:35], v8 offset:4608
ds_read_b128 v[40:43], v11
v_mfma_f32_32x32x16_bf16 v[16:31], v[36:39], v[44:47], v[16:31]
s_waitcnt lgkmcnt(0)
ds_read_b64_tr_b16 v[36:37], v8 offset:6144
ds_read_b64_tr_b16 v[38:39], v8 offset:6656
ds_read_b128 v[44:47], v12
v_mfma_f32_32x32x16_bf16 v[16:31], v[32:35], v[40:43], v[16:31]
s_waitcnt lgkmcnt(0)
s_waitcnt vmcnt(4)
s_barrier
v_add_u32 v8, 16384, v8
v_add_u32 v9, 16384, v9
v_add_u32 v10, 16384, v10
v_add_u32 v11, 16384, v11
v_add_u32 v12, 16384, v12
ds_read_b64_tr_b16 v[32:33], v8 offset:0
ds_read_b64_tr_b16 v[34:35], v8 offset:512
ds_read_b128 v[40:43], v9
v_mfma_f32_32x32x16_bf16 v[16:31], v[36:39], v[44:47], v[16:31]
s_add_u32 m0, s53, 16384
s_add_u32 s55, s50, 1048576
buffer_load_dwordx4 v6, s[8:11], s55 offen lds
s_add_u32 m0, s53, 17408
s_add_u32 s55, s50, 1056768
buffer_load_dwordx4 v6, s[8:11], s55 offen lds
s_waitcnt lgkmcnt(0)
ds_read_b64_tr_b16 v[36:37], v8 offset:2048
ds_read_b64_tr_b16 v[38:39], v8 offset:2560
ds_read_b128 v[44:47], v10
v_mfma_f32_32x32x16_bf16 v[16:31], v[32:35], v[40:43], v[16:31]
s_add_u32 m0, s53, 24576
s_mov_b32 s55, 3072
buffer_load_dwordx4 v7, s[12:15], s55 offen lds
s_add_u32 m0, s53, 25600
s_mov_b32 s55, 39936
v_xor_b32 v5, 16, v7
buffer_load_dwordx4 v5, s[12:15], s55 offen lds
s_waitcnt lgkmcnt(0)
ds_read_b64_tr_b16 v[32:33], v8 offset:4096
ds_read_b64_tr_b16 v[34:35], v8 offset:4608
ds_read_b128 v[40:43], v11
v_mfma_f32_32x32x16_bf16 v[16:31], v[36:39], v[44:47], v[16:31]
s_waitcnt lgkmcnt(0)
ds_read_b64_tr_b16 v[36:37], v8 offset:6144
ds_read_b64_tr_b16 v[38:39], v8 offset:6656
ds_read_b128 v[44:47], v12
v_mfma_f32_32x32x16_bf16 v[16:31], v[32:35], v[40:43], v[16:31]
s_waitcnt lgkmcnt(0)
s_waitcnt vmcnt(4)
s_barrier
v_add_u32 v8, 0xffff8000, v8
v_add_u32 v9, 0xffff8000, v9
v_add_u32 v10, 0xffff8000, v10
v_add_u32 v11, 0xffff8000, v11
v_add_u32 v12, 0xffff8000, v12
ds_read_b64_tr_b16 v[32:33], v8 offset:0
ds_read_b64_tr_b16 v[34:35], v8 offset:512
ds_read_b128 v[40:43], v9
v_mfma_f32_32x32x16_bf16 v[16:31], v[36:39], v[44:47], v[16:31]
s_add_u32 m0, s53, 32768
s_add_u32 s55, s50, 1114112
buffer_load_dwordx4 v6, s[8:11], s55 offen lds
s_add_u32 m0, s53, 33792
s_add_u32 s55, s50, 1122304
buffer_load_dwordx4 v6, s[8:11], s55 offen lds
s_waitcnt lgkmcnt(0)
ds_read_b64_tr_b16 v[36:37], v8 offset:2048
ds_read_b64_tr_b16 v[38:39], v8 offset:2560
ds_read_b128 v[44:47], v10
v_mfma_f32_32x32x16_bf16 v[16:31], v[32:35], v[40:43], v[16:31]
s_add_u32 m0, s53, 40960
s_mov_b32 s55, 3200
buffer_load_dwordx4 v7, s[12:15], s55 offen lds
s_add_u32 m0, s53, 41984
s_mov_b32 s55, 40064
v_xor_b32 v5, 16, v7
buffer_load_dwordx4 v5, s[12:15], s55 offen lds
s_waitcnt lgkmcnt(0)
ds_read_b64_tr_b16 v[32:33], v8 offset:4096
ds_read_b64_tr_b16 v[34:35], v8 offset:4608
ds_read_b128 v[40:43], v11
v_mfma_f32_32x32x16_bf16 v[16:31], v[36:39], v[44:47], v[16:31]
s_waitcnt lgkmcnt(0)
ds_read_b64_tr_b16 v[36:37], v8 offset:6144
ds_read_b64_tr_b16 v[38:39], v8 offset:6656
ds_read_b128 v[44:47], v12
v_mfma_f32_32x32x16_bf16 v[16:31], v[32:35], v[40:43], v[16:31]
s_waitcnt lgkmcnt(0)
s_waitcnt vmcnt(4)
s_barrier
v_add_u32 v8, 16384, v8
v_add_u32 v9, 16384, v9
v_add_u32 v10, 16384, v10
v_add_u32 v11, 16384, v11
v_add_u32 v12, 16384, v12
ds_read_b64_tr_b16 v[32:33], v8 offset:0
ds_read_b64_tr_b16 v[34:35], v8 offset:512
ds_read_b128 v[40:43], v9
v_mfma_f32_32x32x16_bf16 v[16:31], v[36:39], v[44:47], v[16:31]
s_add_u32 m0, s53, 0
s_add_u32 s55, s50, 1179648
buffer_load_dwordx4 v6, s[8:11], s55 offen lds
s_add_u32 m0, s53, 1024
s_add_u32 s55, s50, 1187840
buffer_load_dwordx4 v6, s[8:11], s55 offen lds
s_waitcnt lgkmcnt(0)
ds_read_b64_tr_b16 v[36:37], v8 offset:2048
ds_read_b64_tr_b16 v[38:39], v8 offset:2560
ds_read_b128 v[44:47], v10
v_mfma_f32_32x32x16_bf16 v[16:31], v[32:35], v[40:43], v[16:31]
s_add_u32 m0, s53, 8192
s_mov_b32 s55, 3328
buffer_load_dwordx4 v7, s[12:15], s55 offen lds
s_add_u32 m0, s53, 9216
s_mov_b32 s55, 40192
v_xor_b32 v5, 16, v7
buffer_load_dwordx4 v5, s[12:15], s55 offen lds
s_waitcnt lgkmcnt(0)
ds_read_b64_tr_b16 v[32:33], v8 offset:4096
ds_read_b64_tr_b16 v[34:35], v8 offset:4608
ds_read_b128 v[40:43], v11
v_mfma_f32_32x32x16_bf16 v[16:31], v[36:39], v[44:47], v[16:31]
s_waitcnt lgkmcnt(0)
ds_read_b64_tr_b16 v[36:37], v8 offset:6144
ds_read_b64_tr_b16 v[38:39], v8 offset:6656
ds_read_b128 v[44:47], v12
v_mfma_f32_32x32x16_bf16 v[16:31], v[32:35], v[40:43], v[16:31]
s_waitcnt lgkmcnt(0)
s_waitcnt vmcnt(4)
s_barrier
v_add_u32 v8, 16384, v8
v_add_u32 v9, 16384, v9
v_add_u32 v10, 16384, v10
v_add_u32 v11, 16384, v11
v_add_u32 v12, 16384, v12
ds_read_b64_tr_b16 v[32:33], v8 offset:0
ds_read_b64_tr_b16 v[34:35], v8 offset:512
ds_read_b128 v[40:43], v9
v_mfma_f32_32x32x16_bf16 v[16:31], v[36:39], v[44:47], v[16:31]
s_add_u32 m0, s53, 16384
s_add_u32 s55, s50, 1245184
buffer_load_dwordx4 v6, s[8:11], s55 offen lds
s_add_u32 m0, s53, 17408
s_add_u32 s55, s50, 1253376
buffer_load_dwordx4 v6, s[8:11], s55 offen lds
s_waitcnt lgkmcnt(0)
ds_read_b64_tr_b16 v[36:37], v8 offset:2048
ds_read_b64_tr_b16 v[38:39], v8 offset:2560
ds_read_b128 v[44:47], v10
v_mfma_f32_32x32x16_bf16 v[16:31], v[32:35], v[40:43], v[16:31]
s_add_u32 m0, s53, 24576
s_mov_b32 s55, 3456
buffer_load_dwordx4 v7, s[12:15], s55 offen lds
s_add_u32 m0, s53, 25600
s_mov_b32 s55, 40320
v_xor_b32 v5, 16, v7
buffer_load_dwordx4 v5, s[12:15], s55 offen lds
s_waitcnt lgkmcnt(0)
ds_read_b64_tr_b16 v[32:33], v8 offset:4096
ds_read_b64_tr_b16 v[34:35], v8 offset:4608
ds_read_b128 v[40:43], v11
v_mfma_f32_32x32x16_bf16 v[16:31], v[36:39], v[44:47], v[16:31]
s_waitcnt lgkmcnt(0)
ds_read_b64_tr_b16 v[36:37], v8 offset:6144
ds_read_b64_tr_b16 v[38:39], v8 offset:6656
ds_read_b128 v[44:47], v12
v_mfma_f32_32x32x16_bf16 v[16:31], v[32:35], v[40:43], v[16:31]
s_waitcnt lgkmcnt(0)
s_waitcnt vmcnt(4)
s_barrier
v_add_u32 v8, 0xffff8000, v8
v_add_u32 v9, 0xffff8000, v9
v_add_u32 v10, 0xffff8000, v10
v_add_u32 v11, 0xffff8000, v11
v_add_u32 v12, 0xffff8000, v12
ds_read_b64_tr_b16 v[32:33], v8 offset:0
ds_read_b64_tr_b16 v[34:35], v8 offset:512
ds_read_b128 v[40:43], v9
v_mfma_f32_32x32x16_bf16 v[16:31], v[36:39], v[44:47], v[16:31]
s_add_u32 m0, s53, 32768
s_add_u32 s55, s50, 1310720
buffer_load_dwordx4 v6, s[8:11], s55 offen lds
s_add_u32 m0, s53, 33792
s_add_u32 s55, s50, 1318912
buffer_load_dwordx4 v6, s[8:11], s55 offen lds
s_waitcnt lgkmcnt(0)
ds_read_b64_tr_b16 v[36:37], v8 offset:2048
ds_read_b64_tr_b16 v[38:39], v8 offset:2560
ds_read_b128 v[44:47], v10
v_mfma_f32_32x32x16_bf16 v[16:31], v[32:35], v[40:43], v[16:31]
s_add_u32 m0, s53, 40960
s_mov_b32 s55, 3584
buffer_load_dwordx4 v7, s[12:15], s55 offen lds
s_add_u32 m0, s53, 41984
s_mov_b32 s55, 40448
v_xor_b32 v5, 16, v7
buffer_load_dwordx4 v5, s[12:15], s55 offen lds
s_waitcnt lgkmcnt(0)
ds_read_b64_tr_b16 v[32:33], v8 offset:4096
ds_read_b64_tr_b16 v[34:35], v8 offset:4608
ds_read_b128 v[40:43], v11
v_mfma_f32_32x32x16_bf16 v[16:31], v[36:39], v[44:47], v[16:31]
s_waitcnt lgkmcnt(0)
ds_read_b64_tr_b16 v[36:37], v8 offset:6144
ds_read_b64_tr_b16 v[38:39], v8 offset:6656
ds_read_b128 v[44:47], v12
v_mfma_f32_32x32x16_bf16 v[16:31], v[32:35], v[40:43], v[16:31]
s_waitcnt lgkmcnt(0)
s_waitcnt vmcnt(4)
s_barrier
v_add_u32 v8, 16384, v8
v_add_u32 v9, 16384, v9
v_add_u32 v10, 16384, v10
v_add_u32 v11, 16384, v11
v_add_u32 v12, 16384, v12
ds_read_b64_tr_b16 v[32:33], v8 offset:0
ds_read_b64_tr_b16 v[34:35], v8 offset:512
ds_read_b128 v[40:43], v9
v_mfma_f32_32x32x16_bf16 v[16:31], v[36:39], v[44:47], v[16:31]
s_add_u32 m0, s53, 0
s_add_u32 s55, s50, 1376256
buffer_load_dwordx4 v6, s[8:11], s55 offen lds
s_add_u32 m0, s53, 1024
s_add_u32 s55, s50, 1384448
buffer_load_dwordx4 v6, s[8:11], s55 offen lds
s_waitcnt lgkmcnt(0)
ds_read_b64_tr_b16 v[36:37], v8 offset:2048
ds_read_b64_tr_b16 v[38:39], v8 offset:2560
ds_read_b128 v[44:47], v10
v_mfma_f32_32x32x16_bf16 v[16:31], v[32:35], v[40:43], v[16:31]
s_add_u32 m0, s53, 8192
s_mov_b32 s55, 3712
buffer_load_dwordx4 v7, s[12:15], s55 offen lds
s_add_u32 m0, s53, 9216
s_mov_b32 s55, 40576
v_xor_b32 v5, 16, v7
buffer_load_dwordx4 v5, s[12:15], s55 offen lds
s_waitcnt lgkmcnt(0)
ds_read_b64_tr_b16 v[32:33], v8 offset:4096
ds_read_b64_tr_b16 v[34:35], v8 offset:4608
ds_read_b128 v[40:43], v11
v_mfma_f32_32x32x16_bf16 v[16:31], v[36:39], v[44:47], v[16:31]
s_waitcnt lgkmcnt(0)
ds_read_b64_tr_b16 v[36:37], v8 offset:6144
ds_read_b64_tr_b16 v[38:39], v8 offset:6656
ds_read_b128 v[44:47], v12
v_mfma_f32_32x32x16_bf16 v[16:31], v[32:35], v[40:43], v[16:31]
s_waitcnt lgkmcnt(0)
s_waitcnt vmcnt(4)
s_barrier
v_add_u32 v8, 16384, v8
v_add_u32 v9, 16384, v9
v_add_u32 v10, 16384, v10
v_add_u32 v11, 16384, v11
v_add_u32 v12, 16384, v12
ds_read_b64_tr_b16 v[32:33], v8 offset:0
ds_read_b64_tr_b16 v[34:35], v8 offset:512
ds_read_b128 v[40:43], v9
v_mfma_f32_32x32x16_bf16 v[16:31], v[36:39], v[44:47], v[16:31]
s_add_u32 m0, s53, 16384
s_add_u32 s55, s50, 1441792
buffer_load_dwordx4 v6, s[8:11], s55 offen lds
s_add_u32 m0, s53, 17408
s_add_u32 s55, s50, 1449984
buffer_load_dwordx4 v6, s[8:11], s55 offen lds
s_waitcnt lgkmcnt(0)
ds_read_b64_tr_b16 v[36:37], v8 offset:2048
ds_read_b64_tr_b16 v[38:39], v8 offset:2560
ds_read_b128 v[44:47], v10
v_mfma_f32_32x32x16_bf16 v[16:31], v[32:35], v[40:43], v[16:31]
s_add_u32 m0, s53, 24576
s_mov_b32 s55, 3840
buffer_load_dwordx4 v7, s[12:15], s55 offen lds
s_add_u32 m0, s53, 25600
s_mov_b32 s55, 40704
v_xor_b32 v5, 16, v7
buffer_load_dwordx4 v5, s[12:15], s55 offen lds
s_waitcnt lgkmcnt(0)
ds_read_b64_tr_b16 v[32:33], v8 offset:4096
ds_read_b64_tr_b16 v[34:35], v8 offset:4608
ds_read_b128 v[40:43], v11
v_mfma_f32_32x32x16_bf16 v[16:31], v[36:39], v[44:47], v[16:31]
s_waitcnt lgkmcnt(0)
ds_read_b64_tr_b16 v[36:37], v8 offset:6144
ds_read_b64_tr_b16 v[38:39], v8 offset:6656
ds_read_b128 v[44:47], v12
v_mfma_f32_32x32x16_bf16 v[16:31], v[32:35], v[40:43], v[16:31]
s_waitcnt lgkmcnt(0)
s_waitcnt vmcnt(4)
s_barrier
v_add_u32 v8, 0xffff8000, v8
v_add_u32 v9, 0xffff8000, v9
v_add_u32 v10, 0xffff8000, v10
v_add_u32 v11, 0xffff8000, v11
v_add_u32 v12, 0xffff8000, v12
ds_read_b64_tr_b16 v[32:33], v8 offset:0
ds_read_b64_tr_b16 v[34:35], v8 offset:512
ds_read_b128 v[40:43], v9
v_mfma_f32_32x32x16_bf16 v[16:31], v[36:39], v[44:47], v[16:31]
s_add_u32 m0, s53, 32768
s_add_u32 s55, s50, 1507328
buffer_load_dwordx4 v6, s[8:11], s55 offen lds
s_add_u32 m0, s53, 33792
s_add_u32 s55, s50, 1515520
buffer_load_dwordx4 v6, s[8:11], s55 offen lds
s_waitcnt lgkmcnt(0)
ds_read_b64_tr_b16 v[36:37], v8 offset:2048
ds_read_b64_tr_b16 v[38:39], v8 offset:2560
ds_read_b128 v[44:47], v10
v_mfma_f32_32x32x16_bf16 v[16:31], v[32:35], v[40:43], v[16:31]
s_add_u32 m0, s53, 40960
s_mov_b32 s55, 3968
buffer_load_dwordx4 v7, s[12:15], s55 offen lds
s_add_u32 m0, s53, 41984
s_mov_b32 s55, 40832
v_xor_b32 v5, 16, v7
buffer_load_dwordx4 v5, s[12:15], s55 offen lds
s_waitcnt lgkmcnt(0)
ds_read_b64_tr_b16 v[32:33], v8 offset:4096
ds_read_b64_tr_b16 v[34:35], v8 offset:4608
ds_read_b128 v[40:43], v11
v_mfma_f32_32x32x16_bf16 v[16:31], v[36:39], v[44:47], v[16:31]
s_waitcnt lgkmcnt(0)
ds_read_b64_tr_b16 v[36:37], v8 offset:6144
ds_read_b64_tr_b16 v[38:39], v8 offset:6656
ds_read_b128 v[44:47], v12
v_mfma_f32_32x32x16_bf16 v[16:31], v[32:35], v[40:43], v[16:31]
s_waitcnt lgkmcnt(0)
s_waitcnt vmcnt(4)
s_barrier
v_add_u32 v8, 16384, v8
v_add_u32 v9, 16384, v9
v_add_u32 v10, 16384, v10
v_add_u32 v11, 16384, v11
v_add_u32 v12, 16384, v12
ds_read_b64_tr_b16 v[32:33], v8 offset:0
ds_read_b64_tr_b16 v[34:35], v8 offset:512
ds_read_b128 v[40:43], v9
v_mfma_f32_32x32x16_bf16 v[16:31], v[36:39], v[44:47], v[16:31]
s_add_u32 m0, s53, 0
s_add_u32 s55, s50, 1572864
buffer_load_dwordx4 v6, s[8:11], s55 offen lds
s_add_u32 m0, s53, 1024
s_add_u32 s55, s50, 1581056
buffer_load_dwordx4 v6, s[8:11], s55 offen lds
s_waitcnt lgkmcnt(0)
ds_read_b64_tr_b16 v[36:37], v8 offset:2048
ds_read_b64_tr_b16 v[38:39], v8 offset:2560
ds_read_b128 v[44:47], v10
v_mfma_f32_32x32x16_bf16 v[16:31], v[32:35], v[40:43], v[16:31]
s_add_u32 m0, s53, 8192
s_mov_b32 s55, 4096
buffer_load_dwordx4 v7, s[12:15], s55 offen lds
s_add_u32 m0, s53, 9216
s_mov_b32 s55, 40960
v_xor_b32 v5, 16, v7
buffer_load_dwordx4 v5, s[12:15], s55 offen lds
s_waitcnt lgkmcnt(0)
ds_read_b64_tr_b16 v[32:33], v8 offset:4096
ds_read_b64_tr_b16 v[34:35], v8 offset:4608
ds_read_b128 v[40:43], v11
v_mfma_f32_32x32x16_bf16 v[16:31], v[36:39], v[44:47], v[16:31]
s_waitcnt lgkmcnt(0)
ds_read_b64_tr_b16 v[36:37], v8 offset:6144
ds_read_b64_tr_b16 v[38:39], v8 offset:6656
ds_read_b128 v[44:47], v12
v_mfma_f32_32x32x16_bf16 v[16:31], v[32:35], v[40:43], v[16:31]
s_waitcnt lgkmcnt(0)
s_waitcnt vmcnt(4)
s_barrier
v_add_u32 v8, 16384, v8
v_add_u32 v9, 16384, v9
v_add_u32 v10, 16384, v10
v_add_u32 v11, 16384, v11
v_add_u32 v12, 16384, v12
ds_read_b64_tr_b16 v[32:33], v8 offset:0
ds_read_b64_tr_b16 v[34:35], v8 offset:512
ds_read_b128 v[40:43], v9
v_mfma_f32_32x32x16_bf16 v[16:31], v[36:39], v[44:47], v[16:31]
s_add_u32 m0, s53, 16384
s_add_u32 s55, s50, 1638400
buffer_load_dwordx4 v6, s[8:11], s55 offen lds
s_add_u32 m0, s53, 17408
s_add_u32 s55, s50, 1646592
buffer_load_dwordx4 v6, s[8:11], s55 offen lds
s_waitcnt lgkmcnt(0)
ds_read_b64_tr_b16 v[36:37], v8 offset:2048
ds_read_b64_tr_b16 v[38:39], v8 offset:2560
ds_read_b128 v[44:47], v10
v_mfma_f32_32x32x16_bf16 v[16:31], v[32:35], v[40:43], v[16:31]
s_add_u32 m0, s53, 24576
s_mov_b32 s55, 4224
buffer_load_dwordx4 v7, s[12:15], s55 offen lds
s_add_u32 m0, s53, 25600
s_mov_b32 s55, 41088
v_xor_b32 v5, 16, v7
buffer_load_dwordx4 v5, s[12:15], s55 offen lds
s_waitcnt lgkmcnt(0)
ds_read_b64_tr_b16 v[32:33], v8 offset:4096
ds_read_b64_tr_b16 v[34:35], v8 offset:4608
ds_read_b128 v[40:43], v11
v_mfma_f32_32x32x16_bf16 v[16:31], v[36:39], v[44:47], v[16:31]
s_waitcnt lgkmcnt(0)
ds_read_b64_tr_b16 v[36:37], v8 offset:6144
ds_read_b64_tr_b16 v[38:39], v8 offset:6656
ds_read_b128 v[44:47], v12
v_mfma_f32_32x32x16_bf16 v[16:31], v[32:35], v[40:43], v[16:31]
s_waitcnt lgkmcnt(0)
s_waitcnt vmcnt(4)
s_barrier
v_add_u32 v8, 0xffff8000, v8
v_add_u32 v9, 0xffff8000, v9
v_add_u32 v10, 0xffff8000, v10
v_add_u32 v11, 0xffff8000, v11
v_add_u32 v12, 0xffff8000, v12
ds_read_b64_tr_b16 v[32:33], v8 offset:0
ds_read_b64_tr_b16 v[34:35], v8 offset:512
ds_read_b128 v[40:43], v9
v_mfma_f32_32x32x16_bf16 v[16:31], v[36:39], v[44:47], v[16:31]
s_add_u32 m0, s53, 32768
s_add_u32 s55, s50, 1703936
buffer_load_dwordx4 v6, s[8:11], s55 offen lds
s_add_u32 m0, s53, 33792
s_add_u32 s55, s50, 1712128
buffer_load_dwordx4 v6, s[8:11], s55 offen lds
s_waitcnt lgkmcnt(0)
ds_read_b64_tr_b16 v[36:37], v8 offset:2048
ds_read_b64_tr_b16 v[38:39], v8 offset:2560
ds_read_b128 v[44:47], v10
v_mfma_f32_32x32x16_bf16 v[16:31], v[32:35], v[40:43], v[16:31]
s_add_u32 m0, s53, 40960
s_mov_b32 s55, 4352
buffer_load_dwordx4 v7, s[12:15], s55 offen lds
s_add_u32 m0, s53, 41984
s_mov_b32 s55, 41216
v_xor_b32 v5, 16, v7
buffer_load_dwordx4 v5, s[12:15], s55 offen lds
s_waitcnt lgkmcnt(0)
ds_read_b64_tr_b16 v[32:33], v8 offset:4096
ds_read_b64_tr_b16 v[34:35], v8 offset:4608
ds_read_b128 v[40:43], v11
v_mfma_f32_32x32x16_bf16 v[16:31], v[36:39], v[44:47], v[16:31]
s_waitcnt lgkmcnt(0)
ds_read_b64_tr_b16 v[36:37], v8 offset:6144
ds_read_b64_tr_b16 v[38:39], v8 offset:6656
ds_read_b128 v[44:47], v12
v_mfma_f32_32x32x16_bf16 v[16:31], v[32:35], v[40:43], v[16:31]
s_waitcnt lgkmcnt(0)
s_waitcnt vmcnt(4)
s_barrier
v_add_u32 v8, 16384, v8
v_add_u32 v9, 16384, v9
v_add_u32 v10, 16384, v10
v_add_u32 v11, 16384, v11
v_add_u32 v12, 16384, v12
ds_read_b64_tr_b16 v[32:33], v8 offset:0
ds_read_b64_tr_b16 v[34:35], v8 offset:512
ds_read_b128 v[40:43], v9
v_mfma_f32_32x32x16_bf16 v[16:31], v[36:39], v[44:47], v[16:31]
s_add_u32 m0, s53, 0
s_add_u32 s55, s50, 1769472
buffer_load_dwordx4 v6, s[8:11], s55 offen lds
s_add_u32 m0, s53, 1024
s_add_u32 s55, s50, 1777664
buffer_load_dwordx4 v6, s[8:11], s55 offen lds
s_waitcnt lgkmcnt(0)
ds_read_b64_tr_b16 v[36:37], v8 offset:2048
ds_read_b64_tr_b16 v[38:39], v8 offset:2560
ds_read_b128 v[44:47], v10
v_mfma_f32_32x32x16_bf16 v[16:31], v[32:35], v[40:43], v[16:31]
s_add_u32 m0, s53, 8192
s_mov_b32 s55, 4480
buffer_load_dwordx4 v7, s[12:15], s55 offen lds
s_add_u32 m0, s53, 9216
s_mov_b32 s55, 41344
v_xor_b32 v5, 16, v7
buffer_load_dwordx4 v5, s[12:15], s55 offen lds
s_waitcnt lgkmcnt(0)
ds_read_b64_tr_b16 v[32:33], v8 offset:4096
ds_read_b64_tr_b16 v[34:35], v8 offset:4608
ds_read_b128 v[40:43], v11
v_mfma_f32_32x32x16_bf16 v[16:31], v[36:39], v[44:47], v[16:31]
s_waitcnt lgkmcnt(0)
ds_read_b64_tr_b16 v[36:37], v8 offset:6144
ds_read_b64_tr_b16 v[38:39], v8 offset:6656
ds_read_b128 v[44:47], v12
v_mfma_f32_32x32x16_bf16 v[16:31], v[32:35], v[40:43], v[16:31]
s_waitcnt lgkmcnt(0)
s_waitcnt vmcnt(4)
s_barrier
v_add_u32 v8, 16384, v8
v_add_u32 v9, 16384, v9
v_add_u32 v10, 16384, v10
v_add_u32 v11, 16384, v11
v_add_u32 v12, 16384, v12
ds_read_b64_tr_b16 v[32:33], v8 offset:0
ds_read_b64_tr_b16 v[34:35], v8 offset:512
ds_read_b128 v[40:43], v9
v_mfma_f32_32x32x16_bf16 v[16:31], v[36:39], v[44:47], v[16:31]
s_waitcnt lgkmcnt(0)
ds_read_b64_tr_b16 v[36:37], v8 offset:2048
ds_read_b64_tr_b16 v[38:39], v8 offset:2560
ds_read_b128 v[44:47], v10
v_mfma_f32_32x32x16_bf16 v[16:31], v[32:35], v[40:43], v[16:31]
s_waitcnt lgkmcnt(0)
ds_read_b64_tr_b16 v[32:33], v8 offset:4096
ds_read_b64_tr_b16 v[34:35], v8 offset:4608
ds_read_b128 v[40:43], v11
v_mfma_f32_32x32x16_bf16 v[16:31], v[36:39], v[44:47], v[16:31]
s_waitcnt lgkmcnt(0)
ds_read_b64_tr_b16 v[36:37], v8 offset:6144
ds_read_b64_tr_b16 v[38:39], v8 offset:6656
ds_read_b128 v[44:47], v12
v_mfma_f32_32x32x16_bf16 v[16:31], v[32:35], v[40:43], v[16:31]
s_waitcnt lgkmcnt(0)
s_waitcnt vmcnt(0)
s_barrier
v_add_u32 v8, 0xffff8000, v8
v_add_u32 v9, 0xffff8000, v9
v_add_u32 v10, 0xffff8000, v10
v_add_u32 v11, 0xffff8000, v11
v_add_u32 v12, 0xffff8000, v12
ds_read_b64_tr_b16 v[32:33], v8 offset:0
ds_read_b64_tr_b16 v[34:35], v8 offset:512
ds_read_b128 v[40:43], v9
v_mfma_f32_32x32x16_bf16 v[16:31], v[36:39], v[44:47], v[16:31]
s_waitcnt lgkmcnt(0)
ds_read_b64_tr_b16 v[36:37], v8 offset:2048
ds_read_b64_tr_b16 v[38:39], v8 offset:2560
ds_read_b128 v[44:47], v10
v_mfma_f32_32x32x16_bf16 v[16:31], v[32:35], v[40:43], v[16:31]
s_waitcnt lgkmcnt(0)
ds_read_b64_tr_b16 v[32:33], v8 offset:4096
ds_read_b64_tr_b16 v[34:35], v8 offset:4608
ds_read_b128 v[40:43], v11
v_mfma_f32_32x32x16_bf16 v[16:31], v[36:39], v[44:47], v[16:31]
s_waitcnt lgkmcnt(0)
ds_read_b64_tr_b16 v[36:37], v8 offset:6144
ds_read_b64_tr_b16 v[38:39], v8 offset:6656
ds_read_b128 v[44:47], v12
v_mfma_f32_32x32x16_bf16 v[16:31], v[32:35], v[40:43], v[16:31]
s_waitcnt lgkmcnt(0)
v_mfma_f32_32x32x16_bf16 v[16:31], v[36:39], v[44:47], v[16:31]
v_and_b32 v3, 31, v1
s_lshl_b32 s54, s40, 6
s_lshl_b32 s55, s47, 5
s_add_u32 s54, s54, s55
v_add_u32 v3, s54, v3
v_lshrrev_b32 v4, 5, v1
s_lshl_b32 s54, s41, 6
s_lshl_b32 s55, s48, 5
s_add_u32 s54, s54, s55
v_lshlrev_b32 v4, 2, v4
v_add_u32 v4, s54, v4
s_load_dwordx2 s[42:43], s[0:1], 0
s_load_dwordx2 s[56:57], s[0:1], 56
s_waitcnt lgkmcnt(0)
s_mov_b32 s8, s42
s_mov_b32 s9, s43
s_mov_b32 s10, 2097152
s_mov_b32 s12, s56
s_mov_b32 s13, s57
s_mov_b32 s14, 1024
v_lshlrev_b32 v2, 1, v4
v_lshl_add_u32 v5, v3, 10, v2
buffer_load_dwordx2 v[32:33], v5, s[8:11], 0 offen offset:0
buffer_load_dwordx2 v[40:41], v2, s[12:15], 0 offen offset:0
buffer_load_dwordx2 v[34:35], v5, s[8:11], 0 offen offset:16
buffer_load_dwordx2 v[42:43], v2, s[12:15], 0 offen offset:16
buffer_load_dwordx2 v[36:37], v5, s[8:11], 0 offen offset:32
buffer_load_dwordx2 v[44:45], v2, s[12:15], 0 offen offset:32
buffer_load_dwordx2 v[38:39], v5, s[8:11], 0 offen offset:48
buffer_load_dwordx2 v[46:47], v2, s[12:15], 0 offen offset:48
s_add_u32 s8, s44, 20971520
s_addc_u32 s9, s45, 0
s_mov_b32 s10, 4194304
v_lshlrev_b32 v2, 2, v4
v_lshl_add_u32 v2, v3, 11, v2
s_waitcnt vmcnt(0)
s_nop 4
v_lshlrev_b32 v48, 16, v32
v_and_b32 v49, 0xffff0000, v32
v_lshlrev_b32 v50, 16, v33
v_and_b32 v51, 0xffff0000, v33
v_lshlrev_b32 v52, 16, v40
v_and_b32 v53, 0xffff0000, v40
v_lshlrev_b32 v54, 16, v41
v_and_b32 v55, 0xffff0000, v41
v_add_f32 v16, v16, v52
v_add_f32 v16, v16, v48
v_add_f32 v17, v17, v53
v_add_f32 v17, v17, v49
v_add_f32 v18, v18, v54
v_add_f32 v18, v18, v50
v_add_f32 v19, v19, v55
v_add_f32 v19, v19, v51
buffer_store_dwordx4 v[16:19], v2, s[8:11], 0 offen offset:0
v_lshlrev_b32 v48, 16, v34
v_and_b32 v49, 0xffff0000, v34
v_lshlrev_b32 v50, 16, v35
v_and_b32 v51, 0xffff0000, v35
v_lshlrev_b32 v52, 16, v42
v_and_b32 v53, 0xffff0000, v42
v_lshlrev_b32 v54, 16, v43
v_and_b32 v55, 0xffff0000, v43
v_add_f32 v20, v20, v52
v_add_f32 v20, v20, v48
v_add_f32 v21, v21, v53
v_add_f32 v21, v21, v49
v_add_f32 v22, v22, v54
v_add_f32 v22, v22, v50
v_add_f32 v23, v23, v55
v_add_f32 v23, v23, v51
buffer_store_dwordx4 v[20:23], v2, s[8:11], 0 offen offset:32
v_lshlrev_b32 v48, 16, v36
v_and_b32 v49, 0xffff0000, v36
v_lshlrev_b32 v50, 16, v37
v_and_b32 v51, 0xffff0000, v37
v_lshlrev_b32 v52, 16, v44
v_and_b32 v53, 0xffff0000, v44
v_lshlrev_b32 v54, 16, v45
v_and_b32 v55, 0xffff0000, v45
v_add_f32 v24, v24, v52
v_add_f32 v24, v24, v48
v_add_f32 v25, v25, v53
v_add_f32 v25, v25, v49
v_add_f32 v26, v26, v54
v_add_f32 v26, v26, v50
v_add_f32 v27, v27, v55
v_add_f32 v27, v27, v51
buffer_store_dwordx4 v[24:27], v2, s[8:11], 0 offen offset:64
v_lshlrev_b32 v48, 16, v38
v_and_b32 v49, 0xffff0000, v38
v_lshlrev_b32 v50, 16, v39
v_and_b32 v51, 0xffff0000, v39
v_lshlrev_b32 v52, 16, v46
v_and_b32 v53, 0xffff0000, v46
v_lshlrev_b32 v54, 16, v47
v_and_b32 v55, 0xffff0000, v47
v_add_f32 v28, v28, v52
v_add_f32 v28, v28, v48
v_add_f32 v29, v29, v53
v_add_f32 v29, v29, v49
v_add_f32 v30, v30, v54
v_add_f32 v30, v30, v50
v_add_f32 v31, v31, v55
v_add_f32 v31, v31, v51
buffer_store_dwordx4 v[28:31], v2, s[8:11], 0 offen offset:96
s_waitcnt vmcnt(0)
F2_END:
s_branch K2_END
K2_ATT:
s_cmp_ge_u32 s2, 512
s_cbranch_scc1 K2_END
s_load_dwordx2 s[4:5], s[0:1], 80

v_lshrrev_b32 v1, 6, v0
s_nop 0
v_readfirstlane_b32 s12, v1
s_and_b32 s13, s2, 31
s_lshr_b32 s14, s2, 5
v_and_b32 v2, 63, v0
v_and_b32 v3, 5, v0
v_cmp_eq_u32 vcc, 0, v3
v_mov_b32 v12, 0
v_mov_b32 v13, 0x3f80
s_nop 1
v_cndmask_b32 v12, v12, v13, vcc
v_lshlrev_b32 v13, 2, v0
v_add_u32 v13, 65536, v13
ds_write_b32 v13, v12
ds_write_b32 v13, v12 offset:2048
ds_write_b32 v13, v12 offset:4096
ds_write_b32 v13, v12 offset:6144
v_cmp_gt_u32 vcc, 128, v0
s_and_saveexec_b64 s[20:21], vcc
ds_write_b32 v13, v12 offset:8192
s_mov_b64 exec, s[20:21]
s_waitcnt lgkmcnt(0)
s_mov_b32 s8, s4
s_mov_b32 s9, s5
s_mov_b32 s10, 268435456
s_mov_b32 s11, 0x00020000
s_lshl_b32 s15, s13, 16
s_lshr_b32 s16, s12, 2
s_lshl_b32 s16, s16, 15
s_and_b32 s17, s12, 3
s_lshl_b32 s17, s17, 10
s_add_u32 s16, s16, s17
s_add_u32 s16, s16, s15
s_add_u32 s16, s16, 2097152
s_lshl_b32 s17, s12, 10
s_add_u32 s17, s17, s15
s_add_u32 s17, s17, 4194304
s_lshr_b32 s18, s12, 2
s_lshl_b32 s18, s18, 12
s_and_b32 s19, s12, 3
s_lshl_b32 s19, s19, 10
s_add_u32 s18, s18, s19
s_lshl_b32 s19, s12, 10
s_add_u32 s19, s19, 8192
v_lshlrev_b32 v14, 4, v2
v_lshrrev_b32 v1, 5, v2
v_lshlrev_b32 v1, 15, v1
v_and_b32 v3, 31, v2
s_lshl_b32 s20, s14, 8
s_lshl_b32 s21, s12, 5
s_add_u32 s20, s20, s21
v_add_u32 v3, s20, v3
v_lshl_add_u32 v1, v3, 4, v1
s_add_u32 s21, s15, 0
v_add_u32 v1, s21, v1
buffer_load_dwordx4 v[88:91], v1, s[8:11], 0 offen
s_mov_b32 s23, 0
s_and_b32 s22, s23, 7
s_lshl_b32 s27, s22, 12
s_add_u32 s27, s27, s16
s_and_b32 s28, s23, 3
s_lshl_b32 s28, s28, 14
s_add_u32 s29, s18, s28
s_mov_b32 m0, s29
s_nop 0
buffer_load_dwordx4 v14, s[8:11], s27 offen lds
s_lshl_b32 s27, s22, 13
s_add_u32 s27, s27, s17
s_add_u32 s29, s19, s28
s_mov_b32 m0, s29
s_nop 0
buffer_load_dwordx4 v14, s[8:11], s27 offen lds
s_add_u32 s23, s23, 1
s_and_b32 s22, s23, 7
s_lshl_b32 s27, s22, 12
s_add_u32 s27, s27, s16
s_and_b32 s28, s23, 3
s_lshl_b32 s28, s28, 14
s_add_u32 s29, s18, s28
s_mov_b32 m0, s29
s_nop 0
buffer_load_dwordx4 v14, s[8:11], s27 offen lds
s_lshl_b32 s27, s22, 13
s_add_u32 s27, s27, s17
s_add_u32 s29, s19, s28
s_mov_b32 m0, s29
s_nop 0
buffer_load_dwordx4 v14, s[8:11], s27 offen lds
s_add_u32 s23, s23, 1
s_and_b32 s22, s23, 7
s_lshl_b32 s27, s22, 12
s_add_u32 s27, s27, s16
s_and_b32 s28, s23, 3
s_lshl_b32 s28, s28, 14
s_add_u32 s29, s18, s28
s_mov_b32 m0, s29
s_nop 0
buffer_load_dwordx4 v14, s[8:11], s27 offen lds
s_lshl_b32 s27, s22, 13
s_add_u32 s27, s27, s17
s_add_u32 s29, s19, s28
s_mov_b32 m0, s29
s_nop 0
buffer_load_dwordx4 v14, s[8:11], s27 offen lds
s_add_u32 s23, s23, 1
v_lshrrev_b32 v1, 5, v2
v_lshlrev_b32 v8, 12, v1
v_and_b32 v3, 31, v2
v_lshl_add_u32 v8, v3, 4, v8
v_and_b32 v3, 15, v2
v_lshrrev_b32 v12, 2, v3
v_lshlrev_b32 v12, 5, v12
v_and_b32 v3, 3, v3
v_lshl_add_u32 v12, v3, 3, v12
v_lshl_add_u32 v9, v1, 7, v12
v_add_u32 v9, 8192, v9
v_xor_b32 v13, 1, v1
v_lshl_add_u32 v12, v13, 7, v12
v_add_u32 v12, 65536, v12
v_and_b32 v3, 16, v2
v_cmp_eq_u32 vcc, 0, v3
v_mov_b32 v10, 0
v_mov_b32 v13, -1
s_nop 1
v_cndmask_b32 v10, v10, v13, vcc
v_cndmask_b32 v9, v12, v9, vcc
v_mov_b32 v11, 0xff800000
s_mov_b32 s21, 0x47800000
v_mov_b32 v48, 0
v_mov_b32 v64, 0
v_mov_b32 v49, 0
v_mov_b32 v65, 0
v_mov_b32 v50, 0
v_mov_b32 v66, 0
v_mov_b32 v51, 0
v_mov_b32 v67, 0
v_mov_b32 v52, 0
v_mov_b32 v68, 0
v_mov_b32 v53, 0
v_mov_b32 v69, 0
v_mov_b32 v54, 0
v_mov_b32 v70, 0
v_mov_b32 v55, 0
v_mov_b32 v71, 0
v_mov_b32 v56, 0
v_mov_b32 v72, 0
v_mov_b32 v57, 0
v_mov_b32 v73, 0
v_mov_b32 v58, 0
v_mov_b32 v74, 0
v_mov_b32 v59, 0
v_mov_b32 v75, 0
v_mov_b32 v60, 0
v_mov_b32 v76, 0
v_mov_b32 v61, 0
v_mov_b32 v77, 0
v_mov_b32 v62, 0
v_mov_b32 v78, 0
v_mov_b32 v63, 0
v_mov_b32 v79, 0
s_mov_b32 s24, 0
s_mov_b32 s25, 0
s_mov_b32 s30, 1
s_waitcnt vmcnt(2) lgkmcnt(0)
s_barrier

s_and_b32 s22, s23, 7
s_lshl_b32 s27, s22, 12
s_add_u32 s27, s27, s16
s_and_b32 s28, s23, 3
s_lshl_b32 s28, s28, 14
s_add_u32 s29, s18, s28
s_mov_b32 m0, s29
s_nop 0
buffer_load_dwordx4 v14, s[8:11], s27 offen lds
s_lshl_b32 s27, s22, 13
s_add_u32 s27, s27, s17
s_add_u32 s29, s19, s28
s_mov_b32 m0, s29
s_nop 0
buffer_load_dwordx4 v14, s[8:11], s27 offen lds
s_add_u32 s23, s23, 1

s_add_u32 s26, s24, 16384
s_and_b32 s26, s26, 65535
v_add_u32 v4, s24, v8
v_add_u32 v5, s26, v8
v_and_b32 v1, s24, v10
v_add_u32 v6, v1, v9
v_and_b32 v1, s26, v10
v_add_u32 v7, v1, v9

s_branch K2_SCAN
K2_CHUNK:
v_mov_b32 v104, v64
v_mov_b32 v105, v65
v_mov_b32 v106, v66
v_mov_b32 v107, v67
v_mov_b32 v108, v68
v_mov_b32 v109, v69
v_mov_b32 v110, v70
v_mov_b32 v111, v71
v_mov_b32 v112, v72
v_mov_b32 v113, v73
v_mov_b32 v114, v74
v_mov_b32 v115, v75
v_mov_b32 v116, v76
v_mov_b32 v117, v77
v_mov_b32 v118, v78
v_mov_b32 v119, v79
s_waitcnt lgkmcnt(4)
v_mfma_f32_32x32x16_bf16 v[32:47], v[92:95], v[88:91], v[48:63]
ds_read_b128 v[92:95], v4 offset:1024
v_exp_f32 v16, v16
v_exp_f32 v17, v17
v_exp_f32 v18, v18
v_exp_f32 v19, v19
v_exp_f32 v20, v20
v_exp_f32 v21, v21
v_exp_f32 v22, v22
v_exp_f32 v23, v23
v_cvt_pk_bf16_f32 v80, v16, v17
v_cvt_pk_bf16_f32 v81, v18, v19
v_cvt_pk_bf16_f32 v82, v20, v21
v_cvt_pk_bf16_f32 v83, v22, v23
v_exp_f32 v24, v24
s_waitcnt lgkmcnt(1)
v_mfma_f32_32x32x16_bf16 v[64:79], v[96:99], v[80:83], v[64:79]
v_exp_f32 v25, v25
v_exp_f32 v26, v26
v_exp_f32 v27, v27
v_exp_f32 v28, v28
v_exp_f32 v29, v29
v_exp_f32 v30, v30
v_exp_f32 v31, v31
v_cvt_pk_bf16_f32 v84, v24, v25
v_cvt_pk_bf16_f32 v85, v26, v27
v_cvt_pk_bf16_f32 v86, v28, v29
v_cvt_pk_bf16_f32 v87, v30, v31
s_nop 1
v_mfma_f32_32x32x16_bf16 v[64:79], v[100:103], v[84:87], v[64:79]
ds_read_b64_tr_b16 v[96:97], v6 offset:1024
ds_read_b64_tr_b16 v[98:99], v6 offset:1280
ds_read_b64_tr_b16 v[100:101], v6 offset:1536
ds_read_b64_tr_b16 v[102:103], v6 offset:1792
s_waitcnt lgkmcnt(4)
v_mfma_f32_32x32x16_bf16 v[16:31], v[92:95], v[88:91], v[48:63]
ds_read_b128 v[92:95], v4 offset:1536
v_exp_f32 v32, v32
v_exp_f32 v33, v33
v_exp_f32 v34, v34
v_exp_f32 v35, v35
v_exp_f32 v36, v36
v_exp_f32 v37, v37
v_exp_f32 v38, v38
v_exp_f32 v39, v39
v_cvt_pk_bf16_f32 v80, v32, v33
v_cvt_pk_bf16_f32 v81, v34, v35
v_cvt_pk_bf16_f32 v82, v36, v37
v_cvt_pk_bf16_f32 v83, v38, v39
v_exp_f32 v40, v40
s_waitcnt lgkmcnt(1)
v_mfma_f32_32x32x16_bf16 v[64:79], v[96:99], v[80:83], v[64:79]
v_exp_f32 v41, v41
v_exp_f32 v42, v42
v_exp_f32 v43, v43
v_exp_f32 v44, v44
v_exp_f32 v45, v45
v_exp_f32 v46, v46
v_exp_f32 v47, v47
v_cvt_pk_bf16_f32 v84, v40, v41
v_cvt_pk_bf16_f32 v85, v42, v43
v_cvt_pk_bf16_f32 v86, v44, v45
v_cvt_pk_bf16_f32 v87, v46, v47
s_nop 1
v_mfma_f32_32x32x16_bf16 v[64:79], v[100:103], v[84:87], v[64:79]
ds_read_b64_tr_b16 v[96:97], v6 offset:2048
ds_read_b64_tr_b16 v[98:99], v6 offset:2304
ds_read_b64_tr_b16 v[100:101], v6 offset:2560
ds_read_b64_tr_b16 v[102:103], v6 offset:2816
s_waitcnt lgkmcnt(4)
v_mfma_f32_32x32x16_bf16 v[32:47], v[92:95], v[88:91], v[48:63]
ds_read_b128 v[92:95], v4 offset:2048
v_exp_f32 v16, v16
v_exp_f32 v17, v17
v_exp_f32 v18, v18
v_exp_f32 v19, v19
v_exp_f32 v20, v20
v_exp_f32 v21, v21
v_exp_f32 v22, v22
v_exp_f32 v23, v23
v_cvt_pk_bf16_f32 v80, v16, v17
v_cvt_pk_bf16_f32 v81, v18, v19
v_cvt_pk_bf16_f32 v82, v20, v21
v_cvt_pk_bf16_f32 v83, v22, v23
v_exp_f32 v24, v24
s_waitcnt lgkmcnt(1)
v_mfma_f32_32x32x16_bf16 v[64:79], v[96:99], v[80:83], v[64:79]
v_exp_f32 v25, v25
v_exp_f32 v26, v26
v_exp_f32 v27, v27
v_exp_f32 v28, v28
v_exp_f32 v29, v29
v_exp_f32 v30, v30
v_exp_f32 v31, v31
v_cvt_pk_bf16_f32 v84, v24, v25
v_cvt_pk_bf16_f32 v85, v26, v27
v_cvt_pk_bf16_f32 v86, v28, v29
v_cvt_pk_bf16_f32 v87, v30, v31
s_nop 1
v_mfma_f32_32x32x16_bf16 v[64:79], v[100:103], v[84:87], v[64:79]
ds_read_b64_tr_b16 v[96:97], v6 offset:3072
ds_read_b64_tr_b16 v[98:99], v6 offset:3328
ds_read_b64_tr_b16 v[100:101], v6 offset:3584
ds_read_b64_tr_b16 v[102:103], v6 offset:3840
s_waitcnt lgkmcnt(4)
v_mfma_f32_32x32x16_bf16 v[16:31], v[92:95], v[88:91], v[48:63]
ds_read_b128 v[92:95], v4 offset:2560
v_exp_f32 v32, v32
v_exp_f32 v33, v33
v_exp_f32 v34, v34
v_exp_f32 v35, v35
v_exp_f32 v36, v36
v_exp_f32 v37, v37
v_exp_f32 v38, v38
v_exp_f32 v39, v39
v_cvt_pk_bf16_f32 v80, v32, v33
v_cvt_pk_bf16_f32 v81, v34, v35
v_cvt_pk_bf16_f32 v82, v36, v37
v_cvt_pk_bf16_f32 v83, v38, v39
v_exp_f32 v40, v40
s_waitcnt lgkmcnt(1)
v_mfma_f32_32x32x16_bf16 v[64:79], v[96:99], v[80:83], v[64:79]
v_exp_f32 v41, v41
v_exp_f32 v42, v42
v_exp_f32 v43, v43
v_exp_f32 v44, v44
v_exp_f32 v45, v45
v_exp_f32 v46, v46
v_exp_f32 v47, v47
v_cvt_pk_bf16_f32 v84, v40, v41
v_cvt_pk_bf16_f32 v85, v42, v43
v_cvt_pk_bf16_f32 v86, v44, v45
v_cvt_pk_bf16_f32 v87, v46, v47
s_nop 1
v_mfma_f32_32x32x16_bf16 v[64:79], v[100:103], v[84:87], v[64:79]
ds_read_b64_tr_b16 v[96:97], v6 offset:4096
ds_read_b64_tr_b16 v[98:99], v6 offset:4352
ds_read_b64_tr_b16 v[100:101], v6 offset:4608
ds_read_b64_tr_b16 v[102:103], v6 offset:4864
s_waitcnt lgkmcnt(4)
v_mfma_f32_32x32x16_bf16 v[32:47], v[92:95], v[88:91], v[48:63]
ds_read_b128 v[92:95], v4 offset:3072
v_exp_f32 v16, v16
v_exp_f32 v17, v17
v_exp_f32 v18, v18
v_exp_f32 v19, v19
v_exp_f32 v20, v20
v_exp_f32 v21, v21
v_exp_f32 v22, v22
v_exp_f32 v23, v23
v_cvt_pk_bf16_f32 v80, v16, v17
v_cvt_pk_bf16_f32 v81, v18, v19
v_cvt_pk_bf16_f32 v82, v20, v21
v_cvt_pk_bf16_f32 v83, v22, v23
v_exp_f32 v24, v24
s_waitcnt lgkmcnt(1)
v_mfma_f32_32x32x16_bf16 v[64:79], v[96:99], v[80:83], v[64:79]
v_exp_f32 v25, v25
v_exp_f32 v26, v26
v_exp_f32 v27, v27
v_exp_f32 v28, v28
v_exp_f32 v29, v29
v_exp_f32 v30, v30
v_exp_f32 v31, v31
v_cvt_pk_bf16_f32 v84, v24, v25
v_cvt_pk_bf16_f32 v85, v26, v27
v_cvt_pk_bf16_f32 v86, v28, v29
v_cvt_pk_bf16_f32 v87, v30, v31
s_nop 1
v_mfma_f32_32x32x16_bf16 v[64:79], v[100:103], v[84:87], v[64:79]
ds_read_b64_tr_b16 v[96:97], v6 offset:5120
ds_read_b64_tr_b16 v[98:99], v6 offset:5376
ds_read_b64_tr_b16 v[100:101], v6 offset:5632
ds_read_b64_tr_b16 v[102:103], v6 offset:5888
s_waitcnt lgkmcnt(4)
v_mfma_f32_32x32x16_bf16 v[16:31], v[92:95], v[88:91], v[48:63]
ds_read_b128 v[92:95], v4 offset:3584
v_exp_f32 v32, v32
v_exp_f32 v33, v33
v_exp_f32 v34, v34
v_exp_f32 v35, v35
v_exp_f32 v36, v36
v_exp_f32 v37, v37
v_exp_f32 v38, v38
v_exp_f32 v39, v39
v_cvt_pk_bf16_f32 v80, v32, v33
v_cvt_pk_bf16_f32 v81, v34, v35
v_cvt_pk_bf16_f32 v82, v36, v37
v_cvt_pk_bf16_f32 v83, v38, v39
v_exp_f32 v40, v40
s_waitcnt lgkmcnt(1)
v_mfma_f32_32x32x16_bf16 v[64:79], v[96:99], v[80:83], v[64:79]
v_exp_f32 v41, v41
v_exp_f32 v42, v42
v_exp_f32 v43, v43
v_exp_f32 v44, v44
v_exp_f32 v45, v45
v_exp_f32 v46, v46
v_exp_f32 v47, v47
v_cvt_pk_bf16_f32 v84, v40, v41
v_cvt_pk_bf16_f32 v85, v42, v43
v_cvt_pk_bf16_f32 v86, v44, v45
v_cvt_pk_bf16_f32 v87, v46, v47
s_nop 1
v_mfma_f32_32x32x16_bf16 v[64:79], v[100:103], v[84:87], v[64:79]
ds_read_b64_tr_b16 v[96:97], v6 offset:6144
ds_read_b64_tr_b16 v[98:99], v6 offset:6400
ds_read_b64_tr_b16 v[100:101], v6 offset:6656
ds_read_b64_tr_b16 v[102:103], v6 offset:6912
s_waitcnt lgkmcnt(4)
v_mfma_f32_32x32x16_bf16 v[32:47], v[92:95], v[88:91], v[48:63]
ds_read_b128 v[92:95], v5
v_exp_f32 v16, v16
v_exp_f32 v17, v17
v_exp_f32 v18, v18
v_exp_f32 v19, v19
v_exp_f32 v20, v20
v_exp_f32 v21, v21
v_exp_f32 v22, v22
v_exp_f32 v23, v23
v_cvt_pk_bf16_f32 v80, v16, v17
v_cvt_pk_bf16_f32 v81, v18, v19
v_cvt_pk_bf16_f32 v82, v20, v21
v_cvt_pk_bf16_f32 v83, v22, v23
v_exp_f32 v24, v24
s_waitcnt lgkmcnt(1)
v_mfma_f32_32x32x16_bf16 v[64:79], v[96:99], v[80:83], v[64:79]
v_exp_f32 v25, v25
v_exp_f32 v26, v26
v_exp_f32 v27, v27
v_exp_f32 v28, v28
v_exp_f32 v29, v29
v_exp_f32 v30, v30
v_exp_f32 v31, v31
v_cvt_pk_bf16_f32 v84, v24, v25
v_cvt_pk_bf16_f32 v85, v26, v27
v_cvt_pk_bf16_f32 v86, v28, v29
v_cvt_pk_bf16_f32 v87, v30, v31
s_nop 1
v_mfma_f32_32x32x16_bf16 v[64:79], v[100:103], v[84:87], v[64:79]
ds_read_b64_tr_b16 v[96:97], v6 offset:7168
ds_read_b64_tr_b16 v[98:99], v6 offset:7424
ds_read_b64_tr_b16 v[100:101], v6 offset:7680
ds_read_b64_tr_b16 v[102:103], v6 offset:7936
s_waitcnt lgkmcnt(4)
v_mfma_f32_32x32x16_bf16 v[16:31], v[92:95], v[88:91], v[48:63]
ds_read_b128 v[92:95], v5 offset:512
v_exp_f32 v32, v32
v_exp_f32 v33, v33
v_exp_f32 v34, v34
v_exp_f32 v35, v35
v_exp_f32 v36, v36
v_exp_f32 v37, v37
v_exp_f32 v38, v38
v_exp_f32 v39, v39
v_cvt_pk_bf16_f32 v80, v32, v33
v_cvt_pk_bf16_f32 v81, v34, v35
v_cvt_pk_bf16_f32 v82, v36, v37
v_cvt_pk_bf16_f32 v83, v38, v39
v_exp_f32 v40, v40
s_waitcnt lgkmcnt(1)
v_mfma_f32_32x32x16_bf16 v[64:79], v[96:99], v[80:83], v[64:79]
v_exp_f32 v41, v41
v_exp_f32 v42, v42
v_exp_f32 v43, v43
v_exp_f32 v44, v44
v_exp_f32 v45, v45
v_exp_f32 v46, v46
v_exp_f32 v47, v47
v_cvt_pk_bf16_f32 v84, v40, v41
v_cvt_pk_bf16_f32 v85, v42, v43
v_cvt_pk_bf16_f32 v86, v44, v45
v_cvt_pk_bf16_f32 v87, v46, v47
s_nop 1
v_mfma_f32_32x32x16_bf16 v[64:79], v[100:103], v[84:87], v[64:79]
ds_read_b64_tr_b16 v[96:97], v7
ds_read_b64_tr_b16 v[98:99], v7 offset:256
ds_read_b64_tr_b16 v[100:101], v7 offset:512
ds_read_b64_tr_b16 v[102:103], v7 offset:768
s_add_u32 s25, s25, 1
s_nop 7
s_nop 7
v_cmp_nge_f32 vcc, s21, v72
s_cbranch_vccnz K2_REDO
s_cmp_eq_u32 s25, 8
s_cbranch_scc1 K2_DONE
s_mov_b32 s24, s26
s_waitcnt vmcnt(2) lgkmcnt(0)
s_barrier

s_and_b32 s22, s23, 7
s_lshl_b32 s27, s22, 12
s_add_u32 s27, s27, s16
s_and_b32 s28, s23, 3
s_lshl_b32 s28, s28, 14
s_add_u32 s29, s18, s28
s_mov_b32 m0, s29
s_nop 0
buffer_load_dwordx4 v14, s[8:11], s27 offen lds
s_lshl_b32 s27, s22, 13
s_add_u32 s27, s27, s17
s_add_u32 s29, s19, s28
s_mov_b32 m0, s29
s_nop 0
buffer_load_dwordx4 v14, s[8:11], s27 offen lds
s_add_u32 s23, s23, 1

s_add_u32 s26, s24, 16384
s_and_b32 s26, s26, 65535
v_add_u32 v4, s24, v8
v_add_u32 v5, s26, v8
v_and_b32 v1, s24, v10
v_add_u32 v6, v1, v9
v_and_b32 v1, s26, v10
v_add_u32 v7, v1, v9

s_branch K2_CHUNK
K2_REDO:
s_sub_u32 s25, s25, 1
v_mov_b32 v64, v104
v_mov_b32 v65, v105
v_mov_b32 v66, v106
v_mov_b32 v67, v107
v_mov_b32 v68, v108
v_mov_b32 v69, v109
v_mov_b32 v70, v110
v_mov_b32 v71, v111
v_mov_b32 v72, v112
v_mov_b32 v73, v113
v_mov_b32 v74, v114
v_mov_b32 v75, v115
v_mov_b32 v76, v116
v_mov_b32 v77, v117
v_mov_b32 v78, v118
v_mov_b32 v79, v119
K2_SCAN:
s_waitcnt lgkmcnt(0)
v_mov_b32 v3, 0xff800000
ds_read_b128 v[92:95], v4 offset:0
s_waitcnt lgkmcnt(0)
v_mfma_f32_32x32x16_bf16 v[16:31], v[92:95], v[88:91], v[48:63]
s_nop 15
s_nop 3
v_max3_f32 v3, v16, v17, v3
v_max3_f32 v3, v18, v19, v3
v_max3_f32 v3, v20, v21, v3
v_max3_f32 v3, v22, v23, v3
v_max3_f32 v3, v24, v25, v3
v_max3_f32 v3, v26, v27, v3
v_max3_f32 v3, v28, v29, v3
v_max3_f32 v3, v30, v31, v3
s_cmp_eq_u32 s30, 1
s_cbranch_scc1 K2_SCAN_DONE
ds_read_b128 v[92:95], v4 offset:512
s_waitcnt lgkmcnt(0)
v_mfma_f32_32x32x16_bf16 v[16:31], v[92:95], v[88:91], v[48:63]
s_nop 15
s_nop 3
v_max3_f32 v3, v16, v17, v3
v_max3_f32 v3, v18, v19, v3
v_max3_f32 v3, v20, v21, v3
v_max3_f32 v3, v22, v23, v3
v_max3_f32 v3, v24, v25, v3
v_max3_f32 v3, v26, v27, v3
v_max3_f32 v3, v28, v29, v3
v_max3_f32 v3, v30, v31, v3
ds_read_b128 v[92:95], v4 offset:1024
s_waitcnt lgkmcnt(0)
v_mfma_f32_32x32x16_bf16 v[16:31], v[92:95], v[88:91], v[48:63]
s_nop 15
s_nop 3
v_max3_f32 v3, v16, v17, v3
v_max3_f32 v3, v18, v19, v3
v_max3_f32 v3, v20, v21, v3
v_max3_f32 v3, v22, v23, v3
v_max3_f32 v3, v24, v25, v3
v_max3_f32 v3, v26, v27, v3
v_max3_f32 v3, v28, v29, v3
v_max3_f32 v3, v30, v31, v3
ds_read_b128 v[92:95], v4 offset:1536
s_waitcnt lgkmcnt(0)
v_mfma_f32_32x32x16_bf16 v[16:31], v[92:95], v[88:91], v[48:63]
s_nop 15
s_nop 3
v_max3_f32 v3, v16, v17, v3
v_max3_f32 v3, v18, v19, v3
v_max3_f32 v3, v20, v21, v3
v_max3_f32 v3, v22, v23, v3
v_max3_f32 v3, v24, v25, v3
v_max3_f32 v3, v26, v27, v3
v_max3_f32 v3, v28, v29, v3
v_max3_f32 v3, v30, v31, v3
ds_read_b128 v[92:95], v4 offset:2048
s_waitcnt lgkmcnt(0)
v_mfma_f32_32x32x16_bf16 v[16:31], v[92:95], v[88:91], v[48:63]
s_nop 15
s_nop 3
v_max3_f32 v3, v16, v17, v3
v_max3_f32 v3, v18, v19, v3
v_max3_f32 v3, v20, v21, v3
v_max3_f32 v3, v22, v23, v3
v_max3_f32 v3, v24, v25, v3
v_max3_f32 v3, v26, v27, v3
v_max3_f32 v3, v28, v29, v3
v_max3_f32 v3, v30, v31, v3
ds_read_b128 v[92:95], v4 offset:2560
s_waitcnt lgkmcnt(0)
v_mfma_f32_32x32x16_bf16 v[16:31], v[92:95], v[88:91], v[48:63]
s_nop 15
s_nop 3
v_max3_f32 v3, v16, v17, v3
v_max3_f32 v3, v18, v19, v3
v_max3_f32 v3, v20, v21, v3
v_max3_f32 v3, v22, v23, v3
v_max3_f32 v3, v24, v25, v3
v_max3_f32 v3, v26, v27, v3
v_max3_f32 v3, v28, v29, v3
v_max3_f32 v3, v30, v31, v3
ds_read_b128 v[92:95], v4 offset:3072
s_waitcnt lgkmcnt(0)
v_mfma_f32_32x32x16_bf16 v[16:31], v[92:95], v[88:91], v[48:63]
s_nop 15
s_nop 3
v_max3_f32 v3, v16, v17, v3
v_max3_f32 v3, v18, v19, v3
v_max3_f32 v3, v20, v21, v3
v_max3_f32 v3, v22, v23, v3
v_max3_f32 v3, v24, v25, v3
v_max3_f32 v3, v26, v27, v3
v_max3_f32 v3, v28, v29, v3
v_max3_f32 v3, v30, v31, v3
ds_read_b128 v[92:95], v4 offset:3584
s_waitcnt lgkmcnt(0)
v_mfma_f32_32x32x16_bf16 v[16:31], v[92:95], v[88:91], v[48:63]
s_nop 15
s_nop 3
v_max3_f32 v3, v16, v17, v3
v_max3_f32 v3, v18, v19, v3
v_max3_f32 v3, v20, v21, v3
v_max3_f32 v3, v22, v23, v3
v_max3_f32 v3, v24, v25, v3
v_max3_f32 v3, v26, v27, v3
v_max3_f32 v3, v28, v29, v3
v_max3_f32 v3, v30, v31, v3
K2_SCAN_DONE:
s_mov_b32 s30, 0
v_mov_b32 v1, v3
s_nop 1
v_permlane32_swap_b32 v3, v1
s_nop 1
v_max_f32 v3, v3, v1
v_max_f32 v12, v3, v11
v_exp_f32_e64 v13, -v12
s_nop 0
v_min_f32 v13, 1.0, v13
v_sub_f32 v48, v48, v12
v_sub_f32 v49, v49, v12
v_sub_f32 v50, v50, v12
v_sub_f32 v51, v51, v12
v_sub_f32 v52, v52, v12
v_sub_f32 v53, v53, v12
v_sub_f32 v54, v54, v12
v_sub_f32 v55, v55, v12
v_sub_f32 v56, v56, v12
v_sub_f32 v57, v57, v12
v_sub_f32 v58, v58, v12
v_sub_f32 v59, v59, v12
v_sub_f32 v60, v60, v12
v_sub_f32 v61, v61, v12
v_sub_f32 v62, v62, v12
v_sub_f32 v63, v63, v12
v_mul_f32 v64, v64, v13
v_mul_f32 v65, v65, v13
v_mul_f32 v66, v66, v13
v_mul_f32 v67, v67, v13
v_mul_f32 v68, v68, v13
v_mul_f32 v69, v69, v13
v_mul_f32 v70, v70, v13
v_mul_f32 v71, v71, v13
v_mul_f32 v72, v72, v13
v_mul_f32 v73, v73, v13
v_mul_f32 v74, v74, v13
v_mul_f32 v75, v75, v13
v_mul_f32 v76, v76, v13
v_mul_f32 v77, v77, v13
v_mul_f32 v78, v78, v13
v_mul_f32 v79, v79, v13
v_mov_b32 v11, 0
ds_read_b128 v[92:95], v4
s_waitcnt lgkmcnt(0)
v_mfma_f32_32x32x16_bf16 v[16:31], v[92:95], v[88:91], v[48:63]
ds_read_b128 v[92:95], v4 offset:512
ds_read_b64_tr_b16 v[96:97], v6
ds_read_b64_tr_b16 v[98:99], v6 offset:256
ds_read_b64_tr_b16 v[100:101], v6 offset:512
ds_read_b64_tr_b16 v[102:103], v6 offset:768
s_nop 7
s_branch K2_CHUNK
K2_DONE:

s_nop 7
v_rcp_f32 v13, v72
s_nop 0
v_mul_f32 v64, v64, v13
v_mul_f32 v65, v65, v13
v_mul_f32 v66, v66, v13
v_mul_f32 v67, v67, v13
v_mul_f32 v68, v68, v13
v_mul_f32 v69, v69, v13
v_mul_f32 v70, v70, v13
v_mul_f32 v71, v71, v13
v_cvt_pk_bf16_f32 v80, v64, v65
v_cvt_pk_bf16_f32 v81, v66, v67
v_cvt_pk_bf16_f32 v82, v68, v69
v_cvt_pk_bf16_f32 v83, v70, v71
v_and_b32 v2, 63, v0
v_and_b32 v3, 31, v2
v_add_u32 v3, s20, v3
s_mov_b32 s27, 4608
v_mul_lo_u32 v3, v3, s27
v_lshrrev_b32 v1, 5, v2
v_lshl_add_u32 v3, v1, 3, v3
s_lshl_b32 s27, s13, 5
s_add_u32 s27, s27, 6291456
v_add_u32 v3, s27, v3
buffer_store_dwordx2 v[80:81], v3, s[8:11], 0 offen
buffer_store_dwordx2 v[82:83], v3, s[8:11], 0 offen offset:16
s_waitcnt vmcnt(0)
K2_END:
s_endpgm
.section .rodata,"a"
.p2align 6
.amdhsa_kernel mha_k2_kernel
  .amdhsa_next_free_vgpr 120
  .amdhsa_next_free_sgpr 96
  .amdhsa_accum_offset 120
  .amdhsa_group_segment_fixed_size 0
  .amdhsa_kernarg_size 88
  .amdhsa_user_sgpr_count 2
  .amdhsa_user_sgpr_kernarg_segment_ptr 1
  .amdhsa_system_sgpr_workgroup_id_x 1
.end_amdhsa_kernel
.text
.globl mha_k3_kernel
.p2align 8
.type mha_k3_kernel,@function
mha_k3_kernel:
s_cmp_ge_u32 s2, 256
s_cbranch_scc1 K3_END
s_and_b32 s40, s2, 31
s_lshr_b32 s41, s2, 5
s_load_dwordx2 s[42:43], s[0:1], 16
s_load_dwordx2 s[44:45], s[0:1], 80
v_lshrrev_b32 v2, 6, v0
v_and_b32 v1, 63, v0
v_readfirstlane_b32 s46, v2
s_cmp_ge_u32 s46, 4
s_cbranch_scc1 K3_END
s_and_b32 s47, s46, 1
s_lshr_b32 s48, s46, 1
s_waitcnt lgkmcnt(0)
s_mov_b32 s8, s42
s_mov_b32 s9, s43
s_mov_b32 s10, 524288
s_mov_b32 s11, 0x00020000
s_add_u32 s12, s44, 6291456
s_addc_u32 s13, s45, 0
s_mov_b32 s14, 9437184
s_mov_b32 s15, 0x00020000
v_lshrrev_b32 v2, 3, v1
v_lshrrev_b32 v3, 4, v1
v_and_b32 v3, 1, v3
v_lshlrev_b32 v3, 2, v3
v_and_b32 v4, 7, v1
v_xor_b32 v3, v3, v4
s_lshl_b32 s49, s46, 4
v_add_u32 v2, s49, v2
v_lshlrev_b32 v6, 10, v2
v_lshl_add_u32 v6, v3, 4, v6
s_lshl_b32 s50, s41, 7
v_lshrrev_b32 v3, 3, v1
v_and_b32 v4, 7, v1
v_xor_b32 v4, v4, v3
s_lshl_b32 s51, s46, 1
s_and_b32 s51, s51, 3
v_xor_b32 v4, s51, v4
s_lshl_b32 s51, s40, 6
s_add_u32 s51, s51, s49
v_add_u32 v3, s51, v3
s_mov_b32 s52, 4608
v_mul_lo_u32 v7, v3, s52
v_lshl_add_u32 v7, v4, 4, v7
s_lshl_b32 s53, s46, 11
v_lshrrev_b32 v2, 5, v1
v_and_b32 v3, 15, v1
v_lshrrev_b32 v4, 2, v3
v_lshl_add_u32 v5, v2, 3, v4
v_lshlrev_b32 v5, 7, v5
v_and_b32 v3, 3, v3
v_lshl_add_u32 v5, v3, 3, v5
v_lshrrev_b32 v2, 4, v1
v_and_b32 v2, 1, v2
v_lshl_add_u32 v5, v2, 5, v5
v_lshrrev_b32 v4, 1, v4
v_xor_b32 v2, s48, v4
v_lshl_add_u32 v8, v2, 6, v5
v_and_b32 v2, 31, v1
s_lshl_b32 s54, s47, 5
v_add_u32 v3, s54, v2
v_lshlrev_b32 v3, 7, v3
v_add_u32 v3, 8192, v3
v_and_b32 v4, 7, v2
v_lshrrev_b32 v2, 3, v2
v_xor_b32 v4, v4, v2
v_lshrrev_b32 v2, 5, v1
v_xor_b32 v4, v4, v2
v_lshl_add_u32 v9, v4, 4, v3
v_xor_b32 v10, 32, v9
v_xor_b32 v11, 64, v9
v_xor_b32 v12, 96, v9
v_mov_b32 v16, 0
v_mov_b32 v17, 0
v_mov_b32 v18, 0
v_mov_b32 v19, 0
v_mov_b32 v20, 0
v_mov_b32 v21, 0
v_mov_b32 v22, 0
v_mov_b32 v23, 0
v_mov_b32 v24, 0
v_mov_b32 v25, 0
v_mov_b32 v26, 0
v_mov_b32 v27, 0
v_mov_b32 v28, 0
v_mov_b32 v29, 0
v_mov_b32 v30, 0
v_mov_b32 v31, 0
s_add_u32 m0, s53, 0
s_add_u32 s55, s50, 0
buffer_load_dwordx4 v6, s[8:11], s55 offen lds
s_add_u32 m0, s53, 1024
s_add_u32 s55, s50, 8192
buffer_load_dwordx4 v6, s[8:11], s55 offen lds
s_add_u32 m0, s53, 8192
s_mov_b32 s55, 0
buffer_load_dwordx4 v7, s[12:15], s55 offen lds
s_add_u32 m0, s53, 9216
s_mov_b32 s55, 36864
v_xor_b32 v5, 16, v7
buffer_load_dwordx4 v5, s[12:15], s55 offen lds
s_add_u32 m0, s53, 16384
s_add_u32 s55, s50, 65536
buffer_load_dwordx4 v6, s[8:11], s55 offen lds
s_add_u32 m0, s53, 17408
s_add_u32 s55, s50, 73728
buffer_load_dwordx4 v6, s[8:11], s55 offen lds
s_add_u32 m0, s53, 24576
s_mov_b32 s55, 128
buffer_load_dwordx4 v7, s[12:15], s55 offen lds
s_add_u32 m0, s53, 25600
s_mov_b32 s55, 36992
v_xor_b32 v5, 16, v7
buffer_load_dwordx4 v5, s[12:15], s55 offen lds
s_waitcnt vmcnt(4)
s_barrier
ds_read_b64_tr_b16 v[32:33], v8 offset:0
ds_read_b64_tr_b16 v[34:35], v8 offset:512
ds_read_b128 v[40:43], v9
s_waitcnt lgkmcnt(0)
ds_read_b64_tr_b16 v[36:37], v8 offset:2048
ds_read_b64_tr_b16 v[38:39], v8 offset:2560
ds_read_b128 v[44:47], v10
v_mfma_f32_32x32x16_bf16 v[16:31], v[32:35], v[40:43], v[16:31]
s_add_u32 m0, s53, 32768
s_add_u32 s55, s50, 131072
buffer_load_dwordx4 v6, s[8:11], s55 offen lds
s_add_u32 m0, s53, 33792
s_add_u32 s55, s50, 139264
buffer_load_dwordx4 v6, s[8:11], s55 offen lds
s_waitcnt lgkmcnt(0)
ds_read_b64_tr_b16 v[32:33], v8 offset:4096
ds_read_b64_tr_b16 v[34:35], v8 offset:4608
ds_read_b128 v[40:43], v11
v_mfma_f32_32x32x16_bf16 v[16:31], v[36:39], v[44:47], v[16:31]
s_add_u32 m0, s53, 40960
s_mov_b32 s55, 256
buffer_load_dwordx4 v7, s[12:15], s55 offen lds
s_add_u32 m0, s53, 41984
s_mov_b32 s55, 37120
v_xor_b32 v5, 16, v7
buffer_load_dwordx4 v5, s[12:15], s55 offen lds
s_waitcnt lgkmcnt(0)
ds_read_b64_tr_b16 v[36:37], v8 offset:6144
ds_read_b64_tr_b16 v[38:39], v8 offset:6656
ds_read_b128 v[44:47], v12
v_mfma_f32_32x32x16_bf16 v[16:31], v[32:35], v[40:43], v[16:31]
s_waitcnt lgkmcnt(0)
s_waitcnt vmcnt(4)
s_barrier
v_add_u32 v8, 16384, v8
v_add_u32 v9, 16384, v9
v_add_u32 v10, 16384, v10
v_add_u32 v11, 16384, v11
v_add_u32 v12, 16384, v12
ds_read_b64_tr_b16 v[32:33], v8 offset:0
ds_read_b64_tr_b16 v[34:35], v8 offset:512
ds_read_b128 v[40:43], v9
v_mfma_f32_32x32x16_bf16 v[16:31], v[36:39], v[44:47], v[16:31]
s_add_u32 m0, s53, 0
s_add_u32 s55, s50, 196608
buffer_load_dwordx4 v6, s[8:11], s55 offen lds
s_add_u32 m0, s53, 1024
s_add_u32 s55, s50, 204800
buffer_load_dwordx4 v6, s[8:11], s55 offen lds
s_waitcnt lgkmcnt(0)
ds_read_b64_tr_b16 v[36:37], v8 offset:2048
ds_read_b64_tr_b16 v[38:39], v8 offset:2560
ds_read_b128 v[44:47], v10
v_mfma_f32_32x32x16_bf16 v[16:31], v[32:35], v[40:43], v[16:31]
s_add_u32 m0, s53, 8192
s_mov_b32 s55, 384
buffer_load_dwordx4 v7, s[12:15], s55 offen lds
s_add_u32 m0, s53, 9216
s_mov_b32 s55, 37248
v_xor_b32 v5, 16, v7
buffer_load_dwordx4 v5, s[12:15], s55 offen lds
s_waitcnt lgkmcnt(0)
ds_read_b64_tr_b16 v[32:33], v8 offset:4096
ds_read_b64_tr_b16 v[34:35], v8 offset:4608
ds_read_b128 v[40:43], v11
v_mfma_f32_32x32x16_bf16 v[16:31], v[36:39], v[44:47], v[16:31]
s_waitcnt lgkmcnt(0)
ds_read_b64_tr_b16 v[36:37], v8 offset:6144
ds_read_b64_tr_b16 v[38:39], v8 offset:6656
ds_read_b128 v[44:47], v12
v_mfma_f32_32x32x16_bf16 v[16:31], v[32:35], v[40:43], v[16:31]
s_waitcnt lgkmcnt(0)
s_waitcnt vmcnt(4)
s_barrier
v_add_u32 v8, 16384, v8
v_add_u32 v9, 16384, v9
v_add_u32 v10, 16384, v10
v_add_u32 v11, 16384, v11
v_add_u32 v12, 16384, v12
ds_read_b64_tr_b16 v[32:33], v8 offset:0
ds_read_b64_tr_b16 v[34:35], v8 offset:512
ds_read_b128 v[40:43], v9
v_mfma_f32_32x32x16_bf16 v[16:31], v[36:39], v[44:47], v[16:31]
s_add_u32 m0, s53, 16384
s_add_u32 s55, s50, 262144
buffer_load_dwordx4 v6, s[8:11], s55 offen lds
s_add_u32 m0, s53, 17408
s_add_u32 s55, s50, 270336
buffer_load_dwordx4 v6, s[8:11], s55 offen lds
s_waitcnt lgkmcnt(0)
ds_read_b64_tr_b16 v[36:37], v8 offset:2048
ds_read_b64_tr_b16 v[38:39], v8 offset:2560
ds_read_b128 v[44:47], v10
v_mfma_f32_32x32x16_bf16 v[16:31], v[32:35], v[40:43], v[16:31]
s_add_u32 m0, s53, 24576
s_mov_b32 s55, 512
buffer_load_dwordx4 v7, s[12:15], s55 offen lds
s_add_u32 m0, s53, 25600
s_mov_b32 s55, 37376
v_xor_b32 v5, 16, v7
buffer_load_dwordx4 v5, s[12:15], s55 offen lds
s_waitcnt lgkmcnt(0)
ds_read_b64_tr_b16 v[32:33], v8 offset:4096
ds_read_b64_tr_b16 v[34:35], v8 offset:4608
ds_read_b128 v[40:43], v11
v_mfma_f32_32x32x16_bf16 v[16:31], v[36:39], v[44:47], v[16:31]
s_waitcnt lgkmcnt(0)
ds_read_b64_tr_b16 v[36:37], v8 offset:6144
ds_read_b64_tr_b16 v[38:39], v8 offset:6656
ds_read_b128 v[44:47], v12
v_mfma_f32_32x32x16_bf16 v[16:31], v[32:35], v[40:43], v[16:31]
s_waitcnt lgkmcnt(0)
s_waitcnt vmcnt(4)
s_barrier
v_add_u32 v8, 0xffff8000, v8
v_add_u32 v9, 0xffff8000, v9
v_add_u32 v10, 0xffff8000, v10
v_add_u32 v11, 0xffff8000, v11
v_add_u32 v12, 0xffff8000, v12
ds_read_b64_tr_b16 v[32:33], v8 offset:0
ds_read_b64_tr_b16 v[34:35], v8 offset:512
ds_read_b128 v[40:43], v9
v_mfma_f32_32x32x16_bf16 v[16:31], v[36:39], v[44:47], v[16:31]
s_add_u32 m0, s53, 32768
s_add_u32 s55, s50, 327680
buffer_load_dwordx4 v6, s[8:11], s55 offen lds
s_add_u32 m0, s53, 33792
s_add_u32 s55, s50, 335872
buffer_load_dwordx4 v6, s[8:11], s55 offen lds
s_waitcnt lgkmcnt(0)
ds_read_b64_tr_b16 v[36:37], v8 offset:2048
ds_read_b64_tr_b16 v[38:39], v8 offset:2560
ds_read_b128 v[44:47], v10
v_mfma_f32_32x32x16_bf16 v[16:31], v[32:35], v[40:43], v[16:31]
s_add_u32 m0, s53, 40960
s_mov_b32 s55, 640
buffer_load_dwordx4 v7, s[12:15], s55 offen lds
s_add_u32 m0, s53, 41984
s_mov_b32 s55, 37504
v_xor_b32 v5, 16, v7
buffer_load_dwordx4 v5, s[12:15], s55 offen lds
s_waitcnt lgkmcnt(0)
ds_read_b64_tr_b16 v[32:33], v8 offset:4096
ds_read_b64_tr_b16 v[34:35], v8 offset:4608
ds_read_b128 v[40:43], v11
v_mfma_f32_32x32x16_bf16 v[16:31], v[36:39], v[44:47], v[16:31]
s_waitcnt lgkmcnt(0)
ds_read_b64_tr_b16 v[36:37], v8 offset:6144
ds_read_b64_tr_b16 v[38:39], v8 offset:6656
ds_read_b128 v[44:47], v12
v_mfma_f32_32x32x16_bf16 v[16:31], v[32:35], v[40:43], v[16:31]
s_waitcnt lgkmcnt(0)
s_waitcnt vmcnt(4)
s_barrier
v_add_u32 v8, 16384, v8
v_add_u32 v9, 16384, v9
v_add_u32 v10, 16384, v10
v_add_u32 v11, 16384, v11
v_add_u32 v12, 16384, v12
ds_read_b64_tr_b16 v[32:33], v8 offset:0
ds_read_b64_tr_b16 v[34:35], v8 offset:512
ds_read_b128 v[40:43], v9
v_mfma_f32_32x32x16_bf16 v[16:31], v[36:39], v[44:47], v[16:31]
s_add_u32 m0, s53, 0
s_add_u32 s55, s50, 393216
buffer_load_dwordx4 v6, s[8:11], s55 offen lds
s_add_u32 m0, s53, 1024
s_add_u32 s55, s50, 401408
buffer_load_dwordx4 v6, s[8:11], s55 offen lds
s_waitcnt lgkmcnt(0)
ds_read_b64_tr_b16 v[36:37], v8 offset:2048
ds_read_b64_tr_b16 v[38:39], v8 offset:2560
ds_read_b128 v[44:47], v10
v_mfma_f32_32x32x16_bf16 v[16:31], v[32:35], v[40:43], v[16:31]
s_add_u32 m0, s53, 8192
s_mov_b32 s55, 768
buffer_load_dwordx4 v7, s[12:15], s55 offen lds
s_add_u32 m0, s53, 9216
s_mov_b32 s55, 37632
v_xor_b32 v5, 16, v7
buffer_load_dwordx4 v5, s[12:15], s55 offen lds
s_waitcnt lgkmcnt(0)
ds_read_b64_tr_b16 v[32:33], v8 offset:4096
ds_read_b64_tr_b16 v[34:35], v8 offset:4608
ds_read_b128 v[40:43], v11
v_mfma_f32_32x32x16_bf16 v[16:31], v[36:39], v[44:47], v[16:31]
s_waitcnt lgkmcnt(0)
ds_read_b64_tr_b16 v[36:37], v8 offset:6144
ds_read_b64_tr_b16 v[38:39], v8 offset:6656
ds_read_b128 v[44:47], v12
v_mfma_f32_32x32x16_bf16 v[16:31], v[32:35], v[40:43], v[16:31]
s_waitcnt lgkmcnt(0)
s_waitcnt vmcnt(4)
s_barrier
v_add_u32 v8, 16384, v8
v_add_u32 v9, 16384, v9
v_add_u32 v10, 16384, v10
v_add_u32 v11, 16384, v11
v_add_u32 v12, 16384, v12
ds_read_b64_tr_b16 v[32:33], v8 offset:0
ds_read_b64_tr_b16 v[34:35], v8 offset:512
ds_read_b128 v[40:43], v9
v_mfma_f32_32x32x16_bf16 v[16:31], v[36:39], v[44:47], v[16:31]
s_add_u32 m0, s53, 16384
s_add_u32 s55, s50, 458752
buffer_load_dwordx4 v6, s[8:11], s55 offen lds
s_add_u32 m0, s53, 17408
s_add_u32 s55, s50, 466944
buffer_load_dwordx4 v6, s[8:11], s55 offen lds
s_waitcnt lgkmcnt(0)
ds_read_b64_tr_b16 v[36:37], v8 offset:2048
ds_read_b64_tr_b16 v[38:39], v8 offset:2560
ds_read_b128 v[44:47], v10
v_mfma_f32_32x32x16_bf16 v[16:31], v[32:35], v[40:43], v[16:31]
s_add_u32 m0, s53, 24576
s_mov_b32 s55, 896
buffer_load_dwordx4 v7, s[12:15], s55 offen lds
s_add_u32 m0, s53, 25600
s_mov_b32 s55, 37760
v_xor_b32 v5, 16, v7
buffer_load_dwordx4 v5, s[12:15], s55 offen lds
s_waitcnt lgkmcnt(0)
ds_read_b64_tr_b16 v[32:33], v8 offset:4096
ds_read_b64_tr_b16 v[34:35], v8 offset:4608
ds_read_b128 v[40:43], v11
v_mfma_f32_32x32x16_bf16 v[16:31], v[36:39], v[44:47], v[16:31]
s_waitcnt lgkmcnt(0)
ds_read_b64_tr_b16 v[36:37], v8 offset:6144
ds_read_b64_tr_b16 v[38:39], v8 offset:6656
ds_read_b128 v[44:47], v12
v_mfma_f32_32x32x16_bf16 v[16:31], v[32:35], v[40:43], v[16:31]
s_waitcnt lgkmcnt(0)
s_waitcnt vmcnt(4)
s_barrier
v_add_u32 v8, 0xffff8000, v8
v_add_u32 v9, 0xffff8000, v9
v_add_u32 v10, 0xffff8000, v10
v_add_u32 v11, 0xffff8000, v11
v_add_u32 v12, 0xffff8000, v12
ds_read_b64_tr_b16 v[32:33], v8 offset:0
ds_read_b64_tr_b16 v[34:35], v8 offset:512
ds_read_b128 v[40:43], v9
v_mfma_f32_32x32x16_bf16 v[16:31], v[36:39], v[44:47], v[16:31]
s_waitcnt lgkmcnt(0)
ds_read_b64_tr_b16 v[36:37], v8 offset:2048
ds_read_b64_tr_b16 v[38:39], v8 offset:2560
ds_read_b128 v[44:47], v10
v_mfma_f32_32x32x16_bf16 v[16:31], v[32:35], v[40:43], v[16:31]
s_waitcnt lgkmcnt(0)
ds_read_b64_tr_b16 v[32:33], v8 offset:4096
ds_read_b64_tr_b16 v[34:35], v8 offset:4608
ds_read_b128 v[40:43], v11
v_mfma_f32_32x32x16_bf16 v[16:31], v[36:39], v[44:47], v[16:31]
s_waitcnt lgkmcnt(0)
ds_read_b64_tr_b16 v[36:37], v8 offset:6144
ds_read_b64_tr_b16 v[38:39], v8 offset:6656
ds_read_b128 v[44:47], v12
v_mfma_f32_32x32x16_bf16 v[16:31], v[32:35], v[40:43], v[16:31]
s_waitcnt lgkmcnt(0)
s_waitcnt vmcnt(0)
s_barrier
v_add_u32 v8, 16384, v8
v_add_u32 v9, 16384, v9
v_add_u32 v10, 16384, v10
v_add_u32 v11, 16384, v11
v_add_u32 v12, 16384, v12
ds_read_b64_tr_b16 v[32:33], v8 offset:0
ds_read_b64_tr_b16 v[34:35], v8 offset:512
ds_read_b128 v[40:43], v9
v_mfma_f32_32x32x16_bf16 v[16:31], v[36:39], v[44:47], v[16:31]
s_waitcnt lgkmcnt(0)
ds_read_b64_tr_b16 v[36:37], v8 offset:2048
ds_read_b64_tr_b16 v[38:39], v8 offset:2560
ds_read_b128 v[44:47], v10
v_mfma_f32_32x32x16_bf16 v[16:31], v[32:35], v[40:43], v[16:31]
s_waitcnt lgkmcnt(0)
ds_read_b64_tr_b16 v[32:33], v8 offset:4096
ds_read_b64_tr_b16 v[34:35], v8 offset:4608
ds_read_b128 v[40:43], v11
v_mfma_f32_32x32x16_bf16 v[16:31], v[36:39], v[44:47], v[16:31]
s_waitcnt lgkmcnt(0)
ds_read_b64_tr_b16 v[36:37], v8 offset:6144
ds_read_b64_tr_b16 v[38:39], v8 offset:6656
ds_read_b128 v[44:47], v12
v_mfma_f32_32x32x16_bf16 v[16:31], v[32:35], v[40:43], v[16:31]
s_waitcnt lgkmcnt(0)
v_mfma_f32_32x32x16_bf16 v[16:31], v[36:39], v[44:47], v[16:31]
v_and_b32 v3, 31, v1
s_lshl_b32 s54, s40, 6
s_lshl_b32 s55, s47, 5
s_add_u32 s54, s54, s55
v_add_u32 v3, s54, v3
v_lshrrev_b32 v4, 5, v1
s_lshl_b32 s54, s41, 6
s_lshl_b32 s55, s48, 5
s_add_u32 s54, s54, s55
v_lshlrev_b32 v4, 2, v4
v_add_u32 v4, s54, v4
s_load_dwordx2 s[42:43], s[0:1], 64
s_add_u32 s8, s44, 20971520
s_addc_u32 s9, s45, 0
s_mov_b32 s10, 4194304
v_lshlrev_b32 v2, 2, v4
v_lshl_add_u32 v2, v3, 11, v2
s_waitcnt lgkmcnt(0)
s_mov_b32 s12, s42
s_mov_b32 s13, s43
s_mov_b32 s14, 2097152
buffer_load_dwordx4 v[48:51], v2, s[8:11], 0 offen offset:0
buffer_load_dwordx4 v[52:55], v2, s[8:11], 0 offen offset:32
buffer_load_dwordx4 v[56:59], v2, s[8:11], 0 offen offset:64
buffer_load_dwordx4 v[60:63], v2, s[8:11], 0 offen offset:96
v_lshlrev_b32 v2, 1, v4
v_lshl_add_u32 v2, v3, 10, v2
s_waitcnt vmcnt(0)
s_nop 4
v_add_f32 v16, v16, v48
v_add_f32 v17, v17, v49
v_add_f32 v18, v18, v50
v_add_f32 v19, v19, v51
v_cvt_pk_bf16_f32 v16, v16, v17
v_cvt_pk_bf16_f32 v17, v18, v19
buffer_store_dwordx2 v[16:17], v2, s[12:15], 0 offen offset:0
v_add_f32 v20, v20, v52
v_add_f32 v21, v21, v53
v_add_f32 v22, v22, v54
v_add_f32 v23, v23, v55
v_cvt_pk_bf16_f32 v20, v20, v21
v_cvt_pk_bf16_f32 v21, v22, v23
buffer_store_dwordx2 v[20:21], v2, s[12:15], 0 offen offset:16
v_add_f32 v24, v24, v56
v_add_f32 v25, v25, v57
v_add_f32 v26, v26, v58
v_add_f32 v27, v27, v59
v_cvt_pk_bf16_f32 v24, v24, v25
v_cvt_pk_bf16_f32 v25, v26, v27
buffer_store_dwordx2 v[24:25], v2, s[12:15], 0 offen offset:32
v_add_f32 v28, v28, v60
v_add_f32 v29, v29, v61
v_add_f32 v30, v30, v62
v_add_f32 v31, v31, v63
v_cvt_pk_bf16_f32 v28, v28, v29
v_cvt_pk_bf16_f32 v29, v30, v31
buffer_store_dwordx2 v[28:29], v2, s[12:15], 0 offen offset:48
s_waitcnt vmcnt(0)
K3_END:
s_endpgm
.section .rodata,"a"
.p2align 6
.amdhsa_kernel mha_k3_kernel
  .amdhsa_next_free_vgpr 64
  .amdhsa_next_free_sgpr 96
  .amdhsa_accum_offset 64
  .amdhsa_group_segment_fixed_size 0
  .amdhsa_kernarg_size 88
  .amdhsa_user_sgpr_count 2
  .amdhsa_user_sgpr_kernarg_segment_ptr 1
  .amdhsa_system_sgpr_workgroup_id_x 1
.end_amdhsa_kernel
```
